```python
import torch

def _softmax(x, axis=-1):
    return torch.softmax(x, dim=axis)
def _gelu(x):
    return torch.nn.functional.gelu(x, approximate="tanh")
def _silu(x):
    return torch.nn.functional.silu(x)
def _sigmoid(x):
    return torch.sigmoid(x)
def _layernorm(x, axis=-1, eps=1e-5):
    m = x.mean(dim=axis, keepdim=True)
    v = x.var(dim=axis, keepdim=True, unbiased=False)
    return (x - m) / torch.sqrt(v + eps)
def _scatter_add(tgt, idx, src, axis=0):
    return tgt.clone().index_add_(axis, idx, src)
def _segment_sum(src, seg, n):
    out = torch.zeros((n,) + src.shape[1:], dtype=src.dtype)
    return out.index_add_(0, seg, src)
def _pad(x, pw):
    flat = tuple(v for pair in reversed(pw) for v in pair)
    return torch.nn.functional.pad(x, flat)

kernel_name = 'sequential_preLN__sliding_block_cached__geglu_ffn__decode'

def setup_inputs():

    _w = (lambda a: (lambda t: t.to(torch.bfloat16) if t.is_floating_point() else t)(torch.as_tensor(a)))
    def _A_setup():
        B, Sq, D = 2, 1, 512
        Hq, Hkv, Sk, Dh = 32, 32, 4096, 128
        assert Hq % Hkv == 0, (Hq, Hkv)
        return {
            "x": _w((lambda *s: torch.randn(*s, dtype=torch.bfloat16) * 0.05)(B, Sq, D)),
            "k_cache": _w((lambda *s: torch.randn(*s, dtype=torch.bfloat16) * 3.2)(B, Hkv, Sk, Dh)),
            "v_cache": _w((lambda *s: torch.randn(*s, dtype=torch.bfloat16) * 0.4)(B, Hkv, Sk, Dh)),
            "wq": _w((lambda *s: torch.randn(*s, dtype=torch.bfloat16) * 3.2)(D, Hq * Dh) * (D ** -0.5)),
            "wo": _w((lambda *s: torch.randn(*s, dtype=torch.bfloat16) * 0.4)(Hq * Dh, D) * ((Hq * Dh) ** -0.5)),
        }
    _A_in = _A_setup()

    def _B_setup():
        B, S, D, F = 2, 1, 512, 1376
        return {
            "x": _w((lambda *s: torch.randn(*s, dtype=torch.bfloat16) * 0.05)(B, S, D)),
            "w_gate": _w((lambda *s: torch.randn(*s, dtype=torch.bfloat16) * 0.05)(D, F)),
            "w_up": _w((lambda *s: torch.randn(*s, dtype=torch.bfloat16) * 0.05)(D, F)),
            "w_down": _w((lambda *s: torch.randn(*s, dtype=torch.bfloat16) * 0.05)(F, D)),
        }
    _B_in = _B_setup()

    return {
        "A_x": _A_in["x"],
        "A_k_cache": _A_in["k_cache"],
        "A_v_cache": _A_in["v_cache"],
        "A_wq": _A_in["wq"],
        "A_wo": _A_in["wo"],
        "B_x": _B_in["x"],
        "B_w_gate": _B_in["w_gate"],
        "B_w_up": _B_in["w_up"],
        "B_w_down": _B_in["w_down"],
    }

def reference(A_x, A_k_cache, A_v_cache, A_wq, A_wo, B_x, B_w_gate, B_w_up, B_w_down):
    def _A_ref(x, k_cache, v_cache, wq, wo):
        B, Sq, D = x.shape
        Hq, Dh = 32, 128
        Hkv, Sk = k_cache.shape[1], k_cache.shape[2]
        W = min(4096, max(256, Sk // 4))
        rep = Hq // Hkv
        q = (lambda x, *d: x.permute(*d))((x @ wq).reshape(B, Sq, Hq, Dh), 0, 2, 1, 3)
        k = (lambda x, n, axis: torch.repeat_interleave(x, n, dim=axis))(k_cache[:, :, Sk - W:, :], rep, axis=1)
        v = (lambda x, n, axis: torch.repeat_interleave(x, n, dim=axis))(v_cache[:, :, Sk - W:, :], rep, axis=1)
        scores = torch.einsum("bhqd,bhkd->bhqk", q, k) * (Dh ** -0.5)
        p = _softmax(scores, axis=-1)
        o = torch.einsum("bhqk,bhkd->bhqd", p, v)
        return (lambda x, *d: x.permute(*d))(o, 0, 2, 1, 3).reshape(B, Sq, Hq * Dh) @ wo

    def _B_ref(x, w_gate, w_up, w_down):
        return (_gelu(x @ w_gate) * (x @ w_up)) @ w_down

    x = A_x
    h = x + _A_ref(_layernorm(x, axis=-1), A_k_cache, A_v_cache, A_wq, A_wo)
    h2 = h + _B_ref(_layernorm(h, axis=-1), B_w_gate, B_w_up, B_w_down)
    return h2
```

```asm
; @launch grid=(256,1,1) block=(576,1,1) lds=114688
.amdgcn_target "amdgcn-amd-amdhsa--gfx950"
.text
.globl sequential_preLN__sliding_block_cached__geglu_ffn__decode_kernel
.p2align 8
.type sequential_preLN__sliding_block_cached__geglu_ffn__decode_kernel,@function
sequential_preLN__sliding_block_cached__geglu_ffn__decode_kernel:
    s_load_dwordx16 s[4:19], s[0:1], 0
    s_load_dwordx8 s[20:27], s[0:1], 64
    s_cmpk_ge_u32 s2, 256
    s_cbranch_scc1 L_end
    s_lshr_b32 s33, s2, 3
    s_and_b32 s32, s33, 3
    s_cmp_lg_u32 s32, 3
    s_cbranch_scc1 L_nopf
    s_getpc_b64 s[66:67]
L_pcbase:
    v_mad_u64_u32 v[4:5], vcc, v0, 21, s[66:67]
    global_load_ubyte v8, v[4:5], off offset:61
L_nopf:
    v_lshrrev_b32 v1, 6, v0
    v_and_b32 v0, 63, v0
    s_and_b32 s28, s2, 7
    v_readfirstlane_b32 s3, v1
    s_lshr_b32 s34, s2, 6
    s_lshl2_add_u32 s30, s28, s34
    s_lshl_b32 s42, 1, 26
    s_lshl_b32 s43, 1, 17
    s_sub_u32 s3, s3, 1
    s_cbranch_scc1 L_svc0
    s_cmp_eq_u32 s32, 3
    s_cbranch_scc1 L_helper
    v_lshlrev_b32 v1, 4, v0
    s_and_b32 s64, s2, 32
    s_add_u32 s64, s64, s30
    s_lshl_b32 s64, s64, 10
    s_mul_i32 s65, s32, 86
    s_and_b32 s39, s3, 3
    s_add_u32 s64, s64, s65
    s_add_u32 s64, s64, s39
    s_addk_i32 s64, 768
    s_lshl_b32 s64, s64, 10
    s_movk_i32 s65, 0x1000
    s_cmp_ge_u32 s3, 4
    s_waitcnt lgkmcnt(0)
    s_cselect_b64 s[40:41], s[8:9], s[6:7]
    s_branch L_first
L_svc0:
    v_lshrrev_b32 v3, 4, v0
    v_and_b32 v5, 15, v0
    v_lshlrev_b32 v1, 9, v3
    v_add_lshl_u32 v1, v1, v5, 4
    s_and_b32 s33, s33, 7
    s_lshl_b32 s64, s33, 11
    s_add_u32 s64, s64, s30
    s_lshl_b32 s64, s64, 8
    s_lshl_b32 s65, 1, 15
    s_waitcnt lgkmcnt(0)
    s_mov_b64 s[40:41], s[10:11]
L_first:
    buffer_load_dwordx4 v[8:11], v1, s[40:43], s64 offen nt
    s_add_u32 s64, s64, s65
    buffer_load_dwordx4 v[12:15], v1, s[40:43], s64 offen nt
    s_add_u32 s64, s64, s65
    buffer_load_dwordx4 v[16:19], v1, s[40:43], s64 offen nt
L_first_end:
    s_add_u32 s64, s64, s65
    v_mov_b32 v2, 0
    s_bfe_u32 s31, s2, 0x10005
    s_cmp_lt_i32 s3, 0
    s_cbranch_scc0 L_notsvc
    s_setprio 3
    s_mov_b32 s56, s26
    s_mov_b32 s57, s27
    s_mov_b32 s58, 1576960
    s_mov_b32 s59, 0x20000
    s_lshl3_add_u32 s69, s30, s33
    s_lshl_b32 s69, s69, 10
    s_add_u32 s69, s69, 1114112
    v_and_b32 v6, 7, v0
    v_lshlrev_b32 v6, 7, v6
    buffer_load_dword v142, v6, s[56:59], s69 offen
    v_lshlrev_b32 v6, 5, v0
    v_lshrrev_b32 v7, 5, v0
    v_lshlrev_b32 v7, 10, v7
    v_and_b32 v128, 31, v0
    v_lshl_add_u32 v7, v128, 2, v7
    s_lshl_b32 s66, s33, 7
    s_mov_b32 s44, s4
    s_mov_b32 s45, s5
    s_mov_b32 s46, 2048
    s_mov_b32 s47, 0x20000
    buffer_load_dwordx4 v[72:75], v6, s[44:47], 0 offen
    buffer_load_dwordx4 v[76:79], v6, s[44:47], 0 offen offset:16
    buffer_load_dword v80, v7, s[44:47], s66 offen
    buffer_load_dwordx4 v[20:23], v1, s[40:43], s64 offen nt
    s_add_u32 s64, s64, s65
    buffer_load_dwordx4 v[24:27], v1, s[40:43], s64 offen nt
    s_add_u32 s64, s64, s65
    buffer_load_dwordx4 v[28:31], v1, s[40:43], s64 offen nt
    s_add_u32 s64, s64, s65
    buffer_load_dwordx4 v[32:35], v1, s[40:43], s64 offen nt
    s_add_u32 s64, s64, s65
    buffer_load_dwordx4 v[36:39], v1, s[40:43], s64 offen nt
    s_add_u32 s64, s64, s65
    buffer_load_dwordx4 v[40:43], v1, s[40:43], s64 offen nt
    s_add_u32 s64, s64, s65
    buffer_load_dwordx4 v[44:47], v1, s[40:43], s64 offen nt
    s_add_u32 s64, s64, s65
    buffer_load_dwordx4 v[48:51], v1, s[40:43], s64 offen nt
    s_add_u32 s64, s64, s65
    buffer_load_dwordx4 v[52:55], v1, s[40:43], s64 offen nt
    s_add_u32 s64, s64, s65
    buffer_load_dwordx4 v[56:59], v1, s[40:43], s64 offen nt
    s_add_u32 s64, s64, s65
    buffer_load_dwordx4 v[60:63], v1, s[40:43], s64 offen nt
    s_add_u32 s64, s64, s65
    buffer_load_dwordx4 v[64:67], v1, s[40:43], s64 offen nt
    s_add_u32 s64, s64, s65
    buffer_load_dwordx4 v[68:71], v1, s[40:43], s64 offen nt
    v_mov_b32 v129, 0
    v_mov_b32 v128, 0
    v_lshlrev_b32 v4, 3, v0
    v_and_b32 v4, 56, v4
    ds_write_b64 v4, v[128:129] offset:12224
    v_lshlrev_b32 v1, 4, v0
    s_waitcnt lgkmcnt(0)
    s_barrier
    s_branch L_service
L_notsvc:
    s_movk_i32 s38, 344
    s_cmp_eq_u32 s32, 2
    s_cselect_b32 s38, 336, s38
    s_add_u32 s65, s39, 12
    s_lshl_b32 s65, s65, 10
    s_sub_u32 s42, s64, s65
    s_lshl_b32 s65, s38, 8
    s_add_u32 s42, s42, s65
    s_cmp_ge_u32 s3, 4
    s_setprio 2
    s_waitcnt lgkmcnt(0)
    s_barrier
    s_cbranch_scc1 L_vwave
    buffer_load_dwordx4 v[20:23], v1, s[40:43], s64 offen nt
    s_addk_i32 s64, 0x1000
    buffer_load_dwordx4 v[24:27], v1, s[40:43], s64 offen nt
    s_addk_i32 s64, 0x1000
    buffer_load_dwordx4 v[28:31], v1, s[40:43], s64 offen nt
    s_addk_i32 s64, 0x1000
    s_waitcnt vmcnt(5)
    buffer_load_dwordx4 v[32:35], v1, s[40:43], s64 offen nt
    s_addk_i32 s64, 0x1000
    s_waitcnt vmcnt(5)
    buffer_load_dwordx4 v[36:39], v1, s[40:43], s64 offen nt
    s_addk_i32 s64, 0x1000
    s_waitcnt vmcnt(5)
    buffer_load_dwordx4 v[40:43], v1, s[40:43], s64 offen nt
    s_addk_i32 s64, 0x1000
    s_waitcnt vmcnt(5)
    buffer_load_dwordx4 v[44:47], v1, s[40:43], s64 offen nt
    s_addk_i32 s64, 0x1000
    s_waitcnt vmcnt(5)
    buffer_load_dwordx4 v[48:51], v1, s[40:43], s64 offen nt
    s_addk_i32 s64, 0x1000
    s_waitcnt vmcnt(5)
    buffer_load_dwordx4 v[52:55], v1, s[40:43], s64 offen nt
    s_addk_i32 s64, 0x1000
    s_waitcnt vmcnt(5)
    buffer_load_dwordx4 v[56:59], v1, s[40:43], s64 offen nt
    s_addk_i32 s64, 0x1000
    s_waitcnt vmcnt(5)
    buffer_load_dwordx4 v[60:63], v1, s[40:43], s64 offen nt
    s_addk_i32 s64, 0x1000
    s_waitcnt vmcnt(5)
    buffer_load_dwordx4 v[64:67], v1, s[40:43], s64 offen nt
    s_addk_i32 s64, 0x1000
    s_waitcnt vmcnt(5)
    buffer_load_dwordx4 v[68:71], v1, s[40:43], s64 offen nt
    s_addk_i32 s64, 0x1000
    s_waitcnt vmcnt(5)
    buffer_load_dwordx4 v[72:75], v1, s[40:43], s64 offen nt
    s_addk_i32 s64, 0x1000
    s_waitcnt vmcnt(5)
    buffer_load_dwordx4 v[76:79], v1, s[40:43], s64 offen nt
    s_addk_i32 s64, 0x1000
    s_waitcnt vmcnt(5)
    buffer_load_dwordx4 v[80:83], v1, s[40:43], s64 offen nt
    s_addk_i32 s64, 0x1000
    s_waitcnt vmcnt(5)
    buffer_load_dwordx4 v[84:87], v1, s[40:43], s64 offen nt
    s_addk_i32 s64, 0x1000
    s_waitcnt vmcnt(5)
    buffer_load_dwordx4 v[88:91], v1, s[40:43], s64 offen nt
    s_addk_i32 s64, 0x1000
    s_waitcnt vmcnt(5)
    buffer_load_dwordx4 v[92:95], v1, s[40:43], s64 offen nt
    s_setprio 2
    v_and_b32 v3, 15, v0
    v_lshrrev_b32 v4, 4, v0
    v_lshlrev_b32 v124, 4, v3
    s_lshl_b32 s66, s39, 9
    v_lshlrev_b32 v125, 7, v4
    v_add_u32 v125, s66, v125
    v_lshlrev_b32 v126, 3, v0
    v_add_u32 v126, s66, v126
    v_mov_b32 v127, 0x3fb8aa3b
    s_lshl_b32 s66, s39, 2
    v_lshl_add_u32 v5, v3, 5, v4
    v_add_u32 v5, s66, v5
    v_cmp_gt_u32 s[60:61], s38, v5
    v_add_u32 v5, 16, v5
    v_cmp_gt_u32 s[62:63], s38, v5
    s_lshl_b32 s66, s39, 3
    v_mov_b32 v5, s66
    v_lshrrev_b32 v4, 1, v5
    v_mov_b32 v6, 1
    v_mov_b32 v7, 0xff800000
    s_mov_b32 s76, 262144
L_qwait:
    ds_read_b32 v132, v2 offset:12236
    s_sub_u32 s76, s76, 1
    s_cbranch_scc1 L_qwait_out
    s_waitcnt lgkmcnt(0)
    v_readfirstlane_b32 s77, v132
    s_cmp_eq_u32 s77, 1
    s_cbranch_scc1 L_qwait_out
    s_branch L_qwait
L_qwait_out:
    s_waitcnt lgkmcnt(0)
    ds_read_b128 v[120:123], v124 offset:11776
    s_waitcnt lgkmcnt(0)
    s_waitcnt vmcnt(21)
    v_dot2_f32_bf16 v96, v8, v120, 0
    v_dot2_f32_bf16 v96, v9, v121, v96
    v_dot2_f32_bf16 v96, v10, v122, v96
    v_dot2_f32_bf16 v96, v11, v123, v96
    s_waitcnt vmcnt(20)
    v_dot2_f32_bf16 v97, v12, v120, 0
    v_dot2_f32_bf16 v97, v13, v121, v97
    v_dot2_f32_bf16 v97, v14, v122, v97
    v_dot2_f32_bf16 v97, v15, v123, v97
    s_waitcnt vmcnt(19)
    v_dot2_f32_bf16 v98, v16, v120, 0
    v_dot2_f32_bf16 v98, v17, v121, v98
    v_dot2_f32_bf16 v98, v18, v122, v98
    v_dot2_f32_bf16 v98, v19, v123, v98
    s_waitcnt vmcnt(18)
    v_dot2_f32_bf16 v99, v20, v120, 0
    v_dot2_f32_bf16 v99, v21, v121, v99
    v_dot2_f32_bf16 v99, v22, v122, v99
    v_dot2_f32_bf16 v99, v23, v123, v99
    v_add_f32_dpp v96, v96, v96 row_ror:8 row_mask:0xf bank_mask:0xf
    v_add_f32_dpp v97, v97, v97 row_ror:8 row_mask:0xf bank_mask:0xf
    v_add_f32_dpp v98, v98, v98 row_ror:8 row_mask:0xf bank_mask:0xf
    v_add_f32_dpp v99, v99, v99 row_ror:8 row_mask:0xf bank_mask:0xf
    v_add_f32_dpp v96, v96, v96 row_ror:4 row_mask:0xf bank_mask:0xf
    v_add_f32_dpp v97, v97, v97 row_ror:4 row_mask:0xf bank_mask:0xf
    v_add_f32_dpp v98, v98, v98 row_ror:4 row_mask:0xf bank_mask:0xf
    v_add_f32_dpp v99, v99, v99 row_ror:4 row_mask:0xf bank_mask:0xf
    v_add_f32_dpp v96, v96, v96 row_ror:2 row_mask:0xf bank_mask:0xf
    v_add_f32_dpp v97, v97, v97 row_ror:2 row_mask:0xf bank_mask:0xf
    v_add_f32_dpp v98, v98, v98 row_ror:2 row_mask:0xf bank_mask:0xf
    v_add_f32_dpp v99, v99, v99 row_ror:2 row_mask:0xf bank_mask:0xf
    v_add_f32_dpp v96, v96, v96 row_ror:1 row_mask:0xf bank_mask:0xf
    v_add_f32_dpp v97, v97, v97 row_ror:1 row_mask:0xf bank_mask:0xf
    v_add_f32_dpp v98, v98, v98 row_ror:1 row_mask:0xf bank_mask:0xf
    v_add_f32_dpp v99, v99, v99 row_ror:1 row_mask:0xf bank_mask:0xf
    s_waitcnt vmcnt(17)
    v_dot2_f32_bf16 v100, v24, v120, 0
    v_dot2_f32_bf16 v100, v25, v121, v100
    v_dot2_f32_bf16 v100, v26, v122, v100
    v_dot2_f32_bf16 v100, v27, v123, v100
    s_waitcnt vmcnt(16)
    v_dot2_f32_bf16 v101, v28, v120, 0
    v_dot2_f32_bf16 v101, v29, v121, v101
    v_dot2_f32_bf16 v101, v30, v122, v101
    v_dot2_f32_bf16 v101, v31, v123, v101
    s_waitcnt vmcnt(15)
    v_dot2_f32_bf16 v102, v32, v120, 0
    v_dot2_f32_bf16 v102, v33, v121, v102
    v_dot2_f32_bf16 v102, v34, v122, v102
    v_dot2_f32_bf16 v102, v35, v123, v102
    s_waitcnt vmcnt(14)
    v_dot2_f32_bf16 v103, v36, v120, 0
    v_dot2_f32_bf16 v103, v37, v121, v103
    v_dot2_f32_bf16 v103, v38, v122, v103
    v_dot2_f32_bf16 v103, v39, v123, v103
    v_add_f32_dpp v100, v100, v100 row_ror:8 row_mask:0xf bank_mask:0xf
    v_add_f32_dpp v101, v101, v101 row_ror:8 row_mask:0xf bank_mask:0xf
    v_add_f32_dpp v102, v102, v102 row_ror:8 row_mask:0xf bank_mask:0xf
    v_add_f32_dpp v103, v103, v103 row_ror:8 row_mask:0xf bank_mask:0xf
    v_add_f32_dpp v100, v100, v100 row_ror:4 row_mask:0xf bank_mask:0xf
    v_add_f32_dpp v101, v101, v101 row_ror:4 row_mask:0xf bank_mask:0xf
    v_add_f32_dpp v102, v102, v102 row_ror:4 row_mask:0xf bank_mask:0xf
    v_add_f32_dpp v103, v103, v103 row_ror:4 row_mask:0xf bank_mask:0xf
    v_add_f32_dpp v100, v100, v100 row_ror:2 row_mask:0xf bank_mask:0xf
    v_add_f32_dpp v101, v101, v101 row_ror:2 row_mask:0xf bank_mask:0xf
    v_add_f32_dpp v102, v102, v102 row_ror:2 row_mask:0xf bank_mask:0xf
    v_add_f32_dpp v103, v103, v103 row_ror:2 row_mask:0xf bank_mask:0xf
    v_add_f32_dpp v100, v100, v100 row_ror:1 row_mask:0xf bank_mask:0xf
    v_add_f32_dpp v101, v101, v101 row_ror:1 row_mask:0xf bank_mask:0xf
    v_add_f32_dpp v102, v102, v102 row_ror:1 row_mask:0xf bank_mask:0xf
    v_add_f32_dpp v103, v103, v103 row_ror:1 row_mask:0xf bank_mask:0xf
    s_waitcnt vmcnt(13)
    v_dot2_f32_bf16 v104, v40, v120, 0
    v_dot2_f32_bf16 v104, v41, v121, v104
    v_dot2_f32_bf16 v104, v42, v122, v104
    v_dot2_f32_bf16 v104, v43, v123, v104
    s_waitcnt vmcnt(12)
    v_dot2_f32_bf16 v105, v44, v120, 0
    v_dot2_f32_bf16 v105, v45, v121, v105
    v_dot2_f32_bf16 v105, v46, v122, v105
    v_dot2_f32_bf16 v105, v47, v123, v105
    s_waitcnt vmcnt(11)
    v_dot2_f32_bf16 v106, v48, v120, 0
    v_dot2_f32_bf16 v106, v49, v121, v106
    v_dot2_f32_bf16 v106, v50, v122, v106
    v_dot2_f32_bf16 v106, v51, v123, v106
    s_waitcnt vmcnt(10)
    v_dot2_f32_bf16 v107, v52, v120, 0
    v_dot2_f32_bf16 v107, v53, v121, v107
    v_dot2_f32_bf16 v107, v54, v122, v107
    v_dot2_f32_bf16 v107, v55, v123, v107
    v_add_f32_dpp v104, v104, v104 row_ror:8 row_mask:0xf bank_mask:0xf
    v_add_f32_dpp v105, v105, v105 row_ror:8 row_mask:0xf bank_mask:0xf
    v_add_f32_dpp v106, v106, v106 row_ror:8 row_mask:0xf bank_mask:0xf
    v_add_f32_dpp v107, v107, v107 row_ror:8 row_mask:0xf bank_mask:0xf
    v_add_f32_dpp v104, v104, v104 row_ror:4 row_mask:0xf bank_mask:0xf
    v_add_f32_dpp v105, v105, v105 row_ror:4 row_mask:0xf bank_mask:0xf
    v_add_f32_dpp v106, v106, v106 row_ror:4 row_mask:0xf bank_mask:0xf
    v_add_f32_dpp v107, v107, v107 row_ror:4 row_mask:0xf bank_mask:0xf
    v_add_f32_dpp v104, v104, v104 row_ror:2 row_mask:0xf bank_mask:0xf
    v_add_f32_dpp v105, v105, v105 row_ror:2 row_mask:0xf bank_mask:0xf
    v_add_f32_dpp v106, v106, v106 row_ror:2 row_mask:0xf bank_mask:0xf
    v_add_f32_dpp v107, v107, v107 row_ror:2 row_mask:0xf bank_mask:0xf
    v_add_f32_dpp v104, v104, v104 row_ror:1 row_mask:0xf bank_mask:0xf
    v_add_f32_dpp v105, v105, v105 row_ror:1 row_mask:0xf bank_mask:0xf
    v_add_f32_dpp v106, v106, v106 row_ror:1 row_mask:0xf bank_mask:0xf
    v_add_f32_dpp v107, v107, v107 row_ror:1 row_mask:0xf bank_mask:0xf
    s_waitcnt vmcnt(9)
    v_dot2_f32_bf16 v108, v56, v120, 0
    v_dot2_f32_bf16 v108, v57, v121, v108
    v_dot2_f32_bf16 v108, v58, v122, v108
    v_dot2_f32_bf16 v108, v59, v123, v108
    s_waitcnt vmcnt(8)
    v_dot2_f32_bf16 v109, v60, v120, 0
    v_dot2_f32_bf16 v109, v61, v121, v109
    v_dot2_f32_bf16 v109, v62, v122, v109
    v_dot2_f32_bf16 v109, v63, v123, v109
    s_waitcnt vmcnt(7)
    v_dot2_f32_bf16 v110, v64, v120, 0
    v_dot2_f32_bf16 v110, v65, v121, v110
    v_dot2_f32_bf16 v110, v66, v122, v110
    v_dot2_f32_bf16 v110, v67, v123, v110
    s_waitcnt vmcnt(6)
    v_dot2_f32_bf16 v111, v68, v120, 0
    v_dot2_f32_bf16 v111, v69, v121, v111
    v_dot2_f32_bf16 v111, v70, v122, v111
    v_dot2_f32_bf16 v111, v71, v123, v111
    v_add_f32_dpp v108, v108, v108 row_ror:8 row_mask:0xf bank_mask:0xf
    v_add_f32_dpp v109, v109, v109 row_ror:8 row_mask:0xf bank_mask:0xf
    v_add_f32_dpp v110, v110, v110 row_ror:8 row_mask:0xf bank_mask:0xf
    v_add_f32_dpp v111, v111, v111 row_ror:8 row_mask:0xf bank_mask:0xf
    v_add_f32_dpp v108, v108, v108 row_ror:4 row_mask:0xf bank_mask:0xf
    v_add_f32_dpp v109, v109, v109 row_ror:4 row_mask:0xf bank_mask:0xf
    v_add_f32_dpp v110, v110, v110 row_ror:4 row_mask:0xf bank_mask:0xf
    v_add_f32_dpp v111, v111, v111 row_ror:4 row_mask:0xf bank_mask:0xf
    v_add_f32_dpp v108, v108, v108 row_ror:2 row_mask:0xf bank_mask:0xf
    v_add_f32_dpp v109, v109, v109 row_ror:2 row_mask:0xf bank_mask:0xf
    v_add_f32_dpp v110, v110, v110 row_ror:2 row_mask:0xf bank_mask:0xf
    v_add_f32_dpp v111, v111, v111 row_ror:2 row_mask:0xf bank_mask:0xf
    v_add_f32_dpp v108, v108, v108 row_ror:1 row_mask:0xf bank_mask:0xf
    v_add_f32_dpp v109, v109, v109 row_ror:1 row_mask:0xf bank_mask:0xf
    v_add_f32_dpp v110, v110, v110 row_ror:1 row_mask:0xf bank_mask:0xf
    v_add_f32_dpp v111, v111, v111 row_ror:1 row_mask:0xf bank_mask:0xf
    s_waitcnt vmcnt(5)
    v_dot2_f32_bf16 v112, v72, v120, 0
    v_dot2_f32_bf16 v112, v73, v121, v112
    v_dot2_f32_bf16 v112, v74, v122, v112
    v_dot2_f32_bf16 v112, v75, v123, v112
    s_waitcnt vmcnt(4)
    v_dot2_f32_bf16 v113, v76, v120, 0
    v_dot2_f32_bf16 v113, v77, v121, v113
    v_dot2_f32_bf16 v113, v78, v122, v113
    v_dot2_f32_bf16 v113, v79, v123, v113
    s_waitcnt vmcnt(3)
    v_dot2_f32_bf16 v114, v80, v120, 0
    v_dot2_f32_bf16 v114, v81, v121, v114
    v_dot2_f32_bf16 v114, v82, v122, v114
    v_dot2_f32_bf16 v114, v83, v123, v114
    s_waitcnt vmcnt(2)
    v_dot2_f32_bf16 v115, v84, v120, 0
    v_dot2_f32_bf16 v115, v85, v121, v115
    v_dot2_f32_bf16 v115, v86, v122, v115
    v_dot2_f32_bf16 v115, v87, v123, v115
    v_add_f32_dpp v112, v112, v112 row_ror:8 row_mask:0xf bank_mask:0xf
    v_add_f32_dpp v113, v113, v113 row_ror:8 row_mask:0xf bank_mask:0xf
    v_add_f32_dpp v114, v114, v114 row_ror:8 row_mask:0xf bank_mask:0xf
    v_add_f32_dpp v115, v115, v115 row_ror:8 row_mask:0xf bank_mask:0xf
    v_add_f32_dpp v112, v112, v112 row_ror:4 row_mask:0xf bank_mask:0xf
    v_add_f32_dpp v113, v113, v113 row_ror:4 row_mask:0xf bank_mask:0xf
    v_add_f32_dpp v114, v114, v114 row_ror:4 row_mask:0xf bank_mask:0xf
    v_add_f32_dpp v115, v115, v115 row_ror:4 row_mask:0xf bank_mask:0xf
    v_add_f32_dpp v112, v112, v112 row_ror:2 row_mask:0xf bank_mask:0xf
    v_add_f32_dpp v113, v113, v113 row_ror:2 row_mask:0xf bank_mask:0xf
    v_add_f32_dpp v114, v114, v114 row_ror:2 row_mask:0xf bank_mask:0xf
    v_add_f32_dpp v115, v115, v115 row_ror:2 row_mask:0xf bank_mask:0xf
    v_add_f32_dpp v112, v112, v112 row_ror:1 row_mask:0xf bank_mask:0xf
    v_add_f32_dpp v113, v113, v113 row_ror:1 row_mask:0xf bank_mask:0xf
    v_add_f32_dpp v114, v114, v114 row_ror:1 row_mask:0xf bank_mask:0xf
    v_add_f32_dpp v115, v115, v115 row_ror:1 row_mask:0xf bank_mask:0xf
    s_mov_b32 exec_lo, 0x00010001
    s_mov_b32 exec_hi, 0x00010001
    ds_write_b128 v125, v[96:99] offset:512
    ds_write_b128 v125, v[100:103] offset:528
    ds_write_b128 v125, v[104:107] offset:544
    ds_write_b128 v125, v[108:111] offset:560
    ds_write_b128 v125, v[112:115] offset:576
    s_mov_b64 exec, -1
    s_waitcnt vmcnt(1)
    v_dot2_f32_bf16 v116, v88, v120, 0
    v_dot2_f32_bf16 v116, v89, v121, v116
    v_dot2_f32_bf16 v116, v90, v122, v116
    v_dot2_f32_bf16 v116, v91, v123, v116
    s_waitcnt vmcnt(0)
    v_dot2_f32_bf16 v117, v92, v120, 0
    v_dot2_f32_bf16 v117, v93, v121, v117
    v_dot2_f32_bf16 v117, v94, v122, v117
    v_dot2_f32_bf16 v117, v95, v123, v117
    s_nop 1
    v_add_f32_dpp v116, v116, v116 row_ror:8 row_mask:0xf bank_mask:0xf
    v_add_f32_dpp v117, v117, v117 row_ror:8 row_mask:0xf bank_mask:0xf
    s_nop 0
    v_add_f32_dpp v116, v116, v116 row_ror:4 row_mask:0xf bank_mask:0xf
    v_add_f32_dpp v117, v117, v117 row_ror:4 row_mask:0xf bank_mask:0xf
    s_nop 0
    v_add_f32_dpp v116, v116, v116 row_ror:2 row_mask:0xf bank_mask:0xf
    v_add_f32_dpp v117, v117, v117 row_ror:2 row_mask:0xf bank_mask:0xf
    s_nop 0
    v_add_f32_dpp v116, v116, v116 row_ror:1 row_mask:0xf bank_mask:0xf
    v_add_f32_dpp v117, v117, v117 row_ror:1 row_mask:0xf bank_mask:0xf
    s_mov_b32 exec_lo, 0x00010001
    s_mov_b32 exec_hi, 0x00010001
    ds_write_b128 v125, v[116:119] offset:592
    s_mov_b64 exec, -1
    ds_read_b64 v[128:129], v126 offset:512
    s_waitcnt lgkmcnt(0)
    v_cvt_pk_bf16_f32 v132, v128, v129
    v_lshlrev_b32 v128, 16, v132
    v_and_b32 v129, 0xffff0000, v132
    v_mul_f32 v128, 0x3db504f3, v128
    v_mul_f32 v129, 0x3db504f3, v129
    v_cvt_pk_bf16_f32 v132, v128, v129
    v_lshlrev_b32 v128, 16, v132
    v_and_b32 v129, 0xffff0000, v132
    v_cndmask_b32 v128, v7, v128, s[60:61]
    v_cndmask_b32 v129, v7, v129, s[62:63]
    v_max_f32 v130, v128, v129
    s_nop 1
    v_max_f32_dpp v130, v130, v130 row_ror:8 row_mask:0xf bank_mask:0xf
    s_nop 1
    v_max_f32_dpp v130, v130, v130 row_ror:4 row_mask:0xf bank_mask:0xf
    s_nop 1
    v_max_f32_dpp v130, v130, v130 row_ror:2 row_mask:0xf bank_mask:0xf
    s_nop 1
    v_max_f32_dpp v130, v130, v130 row_ror:1 row_mask:0xf bank_mask:0xf
    s_nop 1
    v_max_f32_dpp v130, v130, v130 row_bcast:15 row_mask:0xa bank_mask:0xf
    s_nop 1
    v_max_f32_dpp v130, v130, v130 row_bcast:31 row_mask:0xc bank_mask:0xf
    v_mul_f32 v130, v127, v130
    s_nop 0
    v_readlane_b32 s66, v130, 63
    s_nop 1
    v_fma_f32 v128, v128, v127, -s66
    v_fma_f32 v129, v129, v127, -s66
    v_exp_f32 v128, v128
    v_exp_f32 v129, v129
    s_nop 0
    v_cvt_pk_bf16_f32 v132, v128, v128
    v_cvt_pk_bf16_f32 v133, v129, v129
    v_add_f32 v131, v128, v129
    ds_write_b64 v126, v[132:133] offset:512
    s_mov_b64 exec, 1
    ds_write_b32 v4, v6 offset:12272
    s_mov_b64 exec, -1
    s_nop 0
    v_add_f32_dpp v131, v131, v131 row_ror:8 row_mask:0xf bank_mask:0xf
    s_nop 1
    v_add_f32_dpp v131, v131, v131 row_ror:4 row_mask:0xf bank_mask:0xf
    s_nop 1
    v_add_f32_dpp v131, v131, v131 row_ror:2 row_mask:0xf bank_mask:0xf
    s_nop 1
    v_add_f32_dpp v131, v131, v131 row_ror:1 row_mask:0xf bank_mask:0xf
    s_nop 1
    v_add_f32_dpp v131, v131, v131 row_bcast:15 row_mask:0xa bank_mask:0xf
    s_nop 1
    v_add_f32_dpp v131, v131, v131 row_bcast:31 row_mask:0xc bank_mask:0xf
    s_mov_b32 exec_lo, 0
    s_mov_b32 exec_hi, 0x80000000
    ds_write_b64 v5, v[130:131] offset:12032
    ds_add_u32 v2, v6 offset:12232
    s_mov_b64 exec, -1
    s_endpgm
L_vwave:
    s_setprio 1
    s_waitcnt vmcnt(1)
    buffer_load_dwordx4 v[20:23], v1, s[40:43], s64 offen nt
    s_addk_i32 s64, 0x1000
    s_load_dword s35, s[26:27], 0
    s_mov_b32 s56, s26
    s_mov_b32 s57, s27
    s_mov_b32 s58, 1576960
    s_mov_b32 s59, 0x20000
    s_lshl_b32 s65, s34, 1
    s_add_u32 s65, s65, s31
    s_add_u32 s66, s65, 16
    s_lshl1_add_u32 s65, s65, s32
    s_cmp_eq_u32 s32, 2
    s_cselect_b32 s65, s66, s65
    s_lshl_b32 s65, s65, 2
    s_add_u32 s65, s65, s39
    s_min_u32 s66, s28, 3
    s_mul_i32 s67, s28, 5
    s_add_u32 s66, s66, s67
    s_cmp_lt_u32 s28, 3
    s_cselect_b32 s67, 6, 5
    s_mov_b32 s50, 1409024
    s_mov_b32 s51, 0x20000
    s_cmp_ge_u32 s65, 64
    s_cbranch_scc1 L_pf_down
    s_cmp_ge_u32 s65, 32
    s_cselect_b32 s48, s18, s16
    s_cselect_b32 s49, s19, s17
    s_and_b32 s65, s65, 31
    s_mul_i32 s65, s65, 44032
    s_lshl_b32 s66, s66, 6
    s_add_u32 s65, s65, s66
    s_lshl_b32 s67, s67, 6
    v_lshrrev_b32 v3, 2, v0
    v_mul_u32_u24 v3, 2752, v3
    v_add_u32 v3, s65, v3
    v_add_u32 v4, s67, v3
    v_and_b32 v3, 0xffffff80, v3
    v_and_b32 v5, 3, v0
    v_lshl_add_u32 v3, v5, 7, v3
    s_branch L_pf_join
L_pf_down:
    s_cmp_lt_u32 s65, 88
    s_cbranch_scc1 L_pf_down2
    s_mov_b32 s48, s12
    s_mov_b32 s49, s13
    s_mov_b32 s50, 4194304
    s_sub_u32 s65, s65, 88
    s_lshl_b32 s65, s65, 13
    s_lshl_b32 s67, s67, 16
    s_add_u32 s65, s65, s67
    s_lshl_b32 s67, s28, 19
    s_add_u32 s65, s65, s67
    v_lshlrev_b32 v3, 7, v0
    v_add_u32 v3, s65, v3
    v_mov_b32 v4, 4194304
    s_branch L_pf_join
L_pf_down2:
    s_mov_b32 s48, s20
    s_mov_b32 s49, s21
    s_sub_u32 s65, s65, 64
    s_lshl_b32 s65, s65, 13
    s_add_u32 s67, s67, s66
    s_lshl_b32 s66, s66, 15
    s_lshl_b32 s67, s67, 15
    s_add_u32 s65, s65, s66
    v_lshlrev_b32 v3, 7, v0
    v_add_u32 v3, s65, v3
    v_mov_b32 v4, s67
    s_mov_b32 s52, 0
    s_mov_b32 s53, s50
    s_branch L_pf_join2
L_pf_join:
    s_mov_b32 s52, s50
    s_mov_b32 s53, 0
L_pf_join2:
    v_cmp_lt_u32 vcc, v3, v4
    v_mov_b32 v4, 0x7ffffff0
    s_nop 0
    v_cndmask_b32 v6, v4, v3, vcc
    buffer_load_dword v7, v6, s[48:51], 0 offen
    s_waitcnt vmcnt(1)
    buffer_load_dwordx4 v[24:27], v1, s[40:43], s64 offen nt
    s_addk_i32 s64, 0x1000
    v_and_b32 v3, 15, v0
    v_and_b32 v4, 1, v0
    v_mov_b32 v5, 0xffff
    v_lshlrev_b32 v4, 4, v4
    v_lshlrev_b32 v5, v4, v5
    v_lshrrev_b32 v4, 1, v3
    v_cmp_eq_u32 vcc, 0, v4
    s_nop 1
    v_cndmask_b32 v120, 0, v5, vcc
    v_cmp_eq_u32 vcc, 1, v4
    s_nop 1
    v_cndmask_b32 v121, 0, v5, vcc
    v_cmp_eq_u32 vcc, 2, v4
    s_nop 1
    v_cndmask_b32 v122, 0, v5, vcc
    v_cmp_eq_u32 vcc, 3, v4
    s_nop 1
    v_cndmask_b32 v123, 0, v5, vcc
    v_lshrrev_b32 v4, 4, v0
    v_lshlrev_b32 v3, 5, v3
    v_lshl_add_u32 v3, v4, 4, v3
    s_lshl_b32 s66, s39, 9
    v_add_u32 v140, s66, v3
    v_lshlrev_b32 v143, 7, v4
    v_add_u32 v143, s66, v143
    v_lshlrev_b32 v141, 3, v0
    v_and_b32 v147, 3, v0
    v_lshlrev_b32 v147, 3, v147
    v_mov_b32 v142, 0xffffff00
    s_lshl_b32 s66, s39, 2
    v_mov_b32 v146, s66
    s_lshl_b32 s68, s30, 1
    s_add_u32 s68, s68, s31
    s_mul_i32 s68, s68, 3
    s_add_u32 s68, s68, s32
    s_mul_i32 s68, s68, 1024
    s_add_u32 s68, s68, 327680
    s_add_u32 s69, s68, 1048576
    s_waitcnt lgkmcnt(0)
    s_waitcnt vmcnt(1)
    buffer_load_dwordx4 v[28:31], v1, s[40:43], s64 offen nt
    s_addk_i32 s64, 0x1000
    s_waitcnt vmcnt(1)
    buffer_load_dwordx4 v[32:35], v1, s[40:43], s64 offen nt
    s_addk_i32 s64, 0x1000
    buffer_load_dwordx4 v[36:39], v1, s[40:43], s64 offen nt
    s_addk_i32 s64, 0x1000
    s_waitcnt vmcnt(7)
    buffer_load_dwordx4 v[40:43], v1, s[40:43], s64 offen nt
    s_addk_i32 s64, 0x1000
    s_waitcnt vmcnt(7)
    buffer_load_dwordx4 v[44:47], v1, s[40:43], s64 offen nt
    s_addk_i32 s64, 0x1000
    s_waitcnt vmcnt(7)
    buffer_load_dwordx4 v[48:51], v1, s[40:43], s64 offen nt
    s_addk_i32 s64, 0x1000
    s_waitcnt vmcnt(7)
    buffer_load_dwordx4 v[52:55], v1, s[40:43], s64 offen nt
    s_addk_i32 s64, 0x1000
    s_waitcnt vmcnt(7)
    buffer_load_dwordx4 v[56:59], v1, s[40:43], s64 offen nt
    s_addk_i32 s64, 0x1000
    s_waitcnt vmcnt(7)
    buffer_load_dwordx4 v[60:63], v1, s[40:43], s64 offen nt
    s_addk_i32 s64, 0x1000
    s_waitcnt vmcnt(7)
    buffer_load_dwordx4 v[64:67], v1, s[40:43], s64 offen nt
    s_addk_i32 s64, 0x1000
    s_waitcnt vmcnt(7)
    buffer_load_dwordx4 v[68:71], v1, s[40:43], s64 offen nt
    s_addk_i32 s64, 0x1000
    s_waitcnt vmcnt(7)
    buffer_load_dwordx4 v[72:75], v1, s[40:43], s64 offen nt
    s_addk_i32 s64, 0x1000
    s_waitcnt vmcnt(7)
    buffer_load_dwordx4 v[76:79], v1, s[40:43], s64 offen nt
    s_addk_i32 s64, 0x1000
    s_waitcnt vmcnt(7)
    buffer_load_dwordx4 v[80:83], v1, s[40:43], s64 offen nt
    s_addk_i32 s64, 0x1000
    s_waitcnt vmcnt(7)
    buffer_load_dwordx4 v[84:87], v1, s[40:43], s64 offen nt
    s_addk_i32 s64, 0x1000
    s_waitcnt vmcnt(7)
    buffer_load_dwordx4 v[88:91], v1, s[40:43], s64 offen nt
    s_addk_i32 s64, 0x1000
    s_waitcnt vmcnt(7)
    buffer_load_dwordx4 v[92:95], v1, s[40:43], s64 offen nt
    s_setprio 2
    s_add_u32 s36, s35, 1
    s_and_b32 s37, s36, 0xff
    s_mov_b32 s76, 262144
L_kwait:
    ds_read_b32 v144, v146 offset:12272
    s_sub_u32 s76, s76, 1
    s_cbranch_scc1 L_kwait_out
    s_waitcnt lgkmcnt(0)
    v_readfirstlane_b32 s77, v144
    s_cmp_eq_u32 s77, 1
    s_cbranch_scc1 L_kwait_out
    s_branch L_kwait
L_kwait_out:
    s_waitcnt lgkmcnt(0)
    ds_read_b128 v[96:99], v143 offset:512
    ds_read_b128 v[100:103], v143 offset:528
    ds_read_b128 v[104:107], v143 offset:544
    ds_read_b128 v[108:111], v143 offset:560
    ds_read_b128 v[112:115], v143 offset:576
    ds_read_b128 v[116:119], v143 offset:592
    s_waitcnt lgkmcnt(5)
    v_and_b32 v128, v96, v120
    v_and_b32 v129, v96, v121
    v_and_b32 v130, v96, v122
    v_and_b32 v131, v96, v123
    v_and_b32 v132, v97, v120
    v_and_b32 v133, v97, v121
    v_and_b32 v134, v97, v122
    v_and_b32 v135, v97, v123
    s_waitcnt vmcnt(22)
    v_mfma_f32_16x16x32_bf16 v[124:127], v[128:131], v[8:11], 0
    v_and_b32 v128, v98, v120
    v_and_b32 v129, v98, v121
    v_and_b32 v130, v98, v122
    v_and_b32 v131, v98, v123
    s_waitcnt vmcnt(21)
    v_mfma_f32_16x16x32_bf16 v[124:127], v[132:135], v[12:15], v[124:127]
    v_and_b32 v132, v99, v120
    v_and_b32 v133, v99, v121
    v_and_b32 v134, v99, v122
    v_and_b32 v135, v99, v123
    s_waitcnt vmcnt(20)
    v_mfma_f32_16x16x32_bf16 v[124:127], v[128:131], v[16:19], v[124:127]
    s_waitcnt lgkmcnt(4)
    v_and_b32 v128, v100, v120
    v_and_b32 v129, v100, v121
    v_and_b32 v130, v100, v122
    v_and_b32 v131, v100, v123
    s_waitcnt vmcnt(19)
    v_mfma_f32_16x16x32_bf16 v[124:127], v[132:135], v[20:23], v[124:127]
    v_and_b32 v132, v101, v120
    v_and_b32 v133, v101, v121
    v_and_b32 v134, v101, v122
    v_and_b32 v135, v101, v123
    s_waitcnt vmcnt(17)
    v_mfma_f32_16x16x32_bf16 v[124:127], v[128:131], v[24:27], v[124:127]
    v_and_b32 v128, v102, v120
    v_and_b32 v129, v102, v121
    v_and_b32 v130, v102, v122
    v_and_b32 v131, v102, v123
    s_waitcnt vmcnt(16)
    v_mfma_f32_16x16x32_bf16 v[124:127], v[132:135], v[28:31], v[124:127]
    v_and_b32 v132, v103, v120
    v_and_b32 v133, v103, v121
    v_and_b32 v134, v103, v122
    v_and_b32 v135, v103, v123
    s_waitcnt vmcnt(15)
    v_mfma_f32_16x16x32_bf16 v[124:127], v[128:131], v[32:35], v[124:127]
    s_waitcnt lgkmcnt(3)
    v_and_b32 v128, v104, v120
    v_and_b32 v129, v104, v121
    v_and_b32 v130, v104, v122
    v_and_b32 v131, v104, v123
    s_waitcnt vmcnt(14)
    v_mfma_f32_16x16x32_bf16 v[124:127], v[132:135], v[36:39], v[124:127]
    v_and_b32 v132, v105, v120
    v_and_b32 v133, v105, v121
    v_and_b32 v134, v105, v122
    v_and_b32 v135, v105, v123
    s_waitcnt vmcnt(13)
    v_mfma_f32_16x16x32_bf16 v[124:127], v[128:131], v[40:43], v[124:127]
    v_and_b32 v128, v106, v120
    v_and_b32 v129, v106, v121
    v_and_b32 v130, v106, v122
    v_and_b32 v131, v106, v123
    s_waitcnt vmcnt(12)
    v_mfma_f32_16x16x32_bf16 v[124:127], v[132:135], v[44:47], v[124:127]
    v_and_b32 v132, v107, v120
    v_and_b32 v133, v107, v121
    v_and_b32 v134, v107, v122
    v_and_b32 v135, v107, v123
    s_waitcnt vmcnt(11)
    v_mfma_f32_16x16x32_bf16 v[124:127], v[128:131], v[48:51], v[124:127]
    s_waitcnt lgkmcnt(2)
    v_and_b32 v128, v108, v120
    v_and_b32 v129, v108, v121
    v_and_b32 v130, v108, v122
    v_and_b32 v131, v108, v123
    s_waitcnt vmcnt(10)
    v_mfma_f32_16x16x32_bf16 v[124:127], v[132:135], v[52:55], v[124:127]
    v_and_b32 v132, v109, v120
    v_and_b32 v133, v109, v121
    v_and_b32 v134, v109, v122
    v_and_b32 v135, v109, v123
    s_waitcnt vmcnt(9)
    v_mfma_f32_16x16x32_bf16 v[124:127], v[128:131], v[56:59], v[124:127]
    v_and_b32 v128, v110, v120
    v_and_b32 v129, v110, v121
    v_and_b32 v130, v110, v122
    v_and_b32 v131, v110, v123
    s_waitcnt vmcnt(8)
    v_mfma_f32_16x16x32_bf16 v[124:127], v[132:135], v[60:63], v[124:127]
    v_and_b32 v132, v111, v120
    v_and_b32 v133, v111, v121
    v_and_b32 v134, v111, v122
    v_and_b32 v135, v111, v123
    s_waitcnt vmcnt(7)
    v_mfma_f32_16x16x32_bf16 v[124:127], v[128:131], v[64:67], v[124:127]
    s_waitcnt lgkmcnt(1)
    v_and_b32 v128, v112, v120
    v_and_b32 v129, v112, v121
    v_and_b32 v130, v112, v122
    v_and_b32 v131, v112, v123
    s_waitcnt vmcnt(6)
    v_mfma_f32_16x16x32_bf16 v[124:127], v[132:135], v[68:71], v[124:127]
    v_and_b32 v132, v113, v120
    v_and_b32 v133, v113, v121
    v_and_b32 v134, v113, v122
    v_and_b32 v135, v113, v123
    s_waitcnt vmcnt(5)
    v_mfma_f32_16x16x32_bf16 v[124:127], v[128:131], v[72:75], v[124:127]
    v_and_b32 v128, v114, v120
    v_and_b32 v129, v114, v121
    v_and_b32 v130, v114, v122
    v_and_b32 v131, v114, v123
    s_waitcnt vmcnt(4)
    v_mfma_f32_16x16x32_bf16 v[124:127], v[132:135], v[76:79], v[124:127]
    v_and_b32 v132, v115, v120
    v_and_b32 v133, v115, v121
    v_and_b32 v134, v115, v122
    v_and_b32 v135, v115, v123
    s_waitcnt vmcnt(3)
    v_mfma_f32_16x16x32_bf16 v[124:127], v[128:131], v[80:83], v[124:127]
    s_mov_b32 s76, 262144
L_kall:
    ds_read_b32 v144, v2 offset:12232
    s_sub_u32 s76, s76, 1
    s_cbranch_scc1 L_kall_out
    s_waitcnt lgkmcnt(0)
    v_readfirstlane_b32 s77, v144
    s_cmp_eq_u32 s77, 4
    s_cbranch_scc1 L_kall_out
    s_branch L_kall
L_kall_out:
    s_waitcnt lgkmcnt(0)
    ds_read_b64 v[144:145], v147 offset:12032
    s_waitcnt lgkmcnt(0)
    v_max_f32_dpp v138, v144, v144 quad_perm:[1,0,3,2] row_mask:0xf bank_mask:0xf
    s_nop 1
    v_max_f32_dpp v138, v138, v138 quad_perm:[2,3,0,1] row_mask:0xf bank_mask:0xf
    v_and_b32 v138, v142, v138
    v_sub_f32 v144, v144, v138
    v_exp_f32 v144, v144
    v_or_b32 v138, s37, v138
    v_mul_f32 v139, v144, v145
    v_readlane_b32 s66, v144, s39
    s_nop 0
    v_add_f32_dpp v139, v139, v139 quad_perm:[1,0,3,2] row_mask:0xf bank_mask:0xf
    s_nop 1
    v_add_f32_dpp v139, v139, v139 quad_perm:[2,3,0,1] row_mask:0xf bank_mask:0xf
    v_and_or_b32 v139, v139, v142, s37
    v_and_b32 v128, v116, v120
    v_and_b32 v129, v116, v121
    v_and_b32 v130, v116, v122
    v_and_b32 v131, v116, v123
    s_waitcnt vmcnt(2)
    v_mfma_f32_16x16x32_bf16 v[124:127], v[132:135], v[84:87], v[124:127]
    v_and_b32 v132, v117, v120
    v_and_b32 v133, v117, v121
    v_and_b32 v134, v117, v122
    v_and_b32 v135, v117, v123
    s_waitcnt vmcnt(1)
    v_mfma_f32_16x16x32_bf16 v[124:127], v[128:131], v[88:91], v[124:127]
    s_nop 0
    s_waitcnt vmcnt(0)
    v_mfma_f32_16x16x32_bf16 v[124:127], v[132:135], v[92:95], v[124:127]
    s_mov_b32 exec_hi, 0
    s_cmp_eq_u32 s39, 0
    s_cselect_b32 s68, s69, s68
    s_cmp_gt_u32 s39, 1
    s_nop 3
    v_mul_f32 v124, s66, v124
    v_mul_f32 v125, s66, v125
    v_mul_f32 v126, s66, v126
    v_mul_f32 v127, s66, v127
    ds_write_b128 v140, v[124:127] offset:2560
    s_mov_b64 exec, -1
    s_waitcnt lgkmcnt(0)
    s_barrier
    s_cbranch_scc1 L_end
    ds_read_b64 v[8:9], v141 offset:2560
    ds_read_b64 v[10:11], v141 offset:3072
    ds_read_b64 v[12:13], v141 offset:3584
    ds_read_b64 v[14:15], v141 offset:4096
    s_cmp_eq_u32 s39, 0
    s_waitcnt lgkmcnt(2)
    v_pk_add_f32 v[8:9], v[8:9], v[10:11]
    s_waitcnt lgkmcnt(0)
    v_pk_add_f32 v[12:13], v[12:13], v[14:15]
    v_pk_add_f32 v[136:137], v[8:9], v[12:13]
    v_and_or_b32 v136, v136, v142, s37
    v_and_or_b32 v137, v137, v142, s37
    s_cbranch_scc0 L_o_global
    buffer_store_dwordx4 v[136:139], v1, s[56:59], s68 offen
    s_endpgm
L_o_global:
    buffer_store_dwordx4 v[136:139], v1, s[56:59], s68 offen sc1
    s_endpgm
L_service:
    s_load_dword s35, s[26:27], 0
    v_and_b32 v6, 1, v0
    v_mov_b32 v7, 0xffff
    v_lshlrev_b32 v6, 4, v6
    v_lshlrev_b32 v7, v6, v7
    v_bfe_u32 v6, v0, 1, 2
    v_cmp_eq_u32 vcc, 0, v6
    s_nop 1
    v_cndmask_b32 v112, 0, v7, vcc
    v_cmp_eq_u32 vcc, 1, v6
    s_nop 1
    v_cndmask_b32 v113, 0, v7, vcc
    v_cmp_eq_u32 vcc, 2, v6
    s_nop 1
    v_cndmask_b32 v114, 0, v7, vcc
    v_cmp_eq_u32 vcc, 3, v6
    s_nop 1
    v_cndmask_b32 v115, 0, v7, vcc
    s_mov_b32 s56, s26
    s_mov_b32 s57, s27
    s_mov_b32 s58, 1576960
    s_mov_b32 s59, 0x20000
    v_and_b32 v6, 1, v0
    v_lshlrev_b32 v6, 7, v6
    v_bfe_u32 v7, v0, 1, 4
    v_lshl_add_u32 v6, v7, 2, v6
    v_lshrrev_b32 v7, 5, v0
    v_lshl_add_u32 v6, v7, 8, v6
    v_bfe_u32 v7, v0, 3, 1
    v_lshlrev_b32 v7, 8, v7
    v_lshl_add_u32 v7, v3, 6, v7
    s_lshl_b32 s68, s30, 3
    s_add_u32 s68, s68, s33
    s_lshl_b32 s68, s68, 10
    s_add_u32 s68, s68, 65536
    s_add_u32 s69, s68, 1048576
    v_mov_b32 v132, 0xffffff00
    s_mov_b32 s39, 0x3f803f80
    s_waitcnt vmcnt(14)
    v_dot2_f32_bf16 v128, v72, s39, 0
    v_dot2_f32_bf16 v129, v72, v72, 0
    v_dot2_f32_bf16 v130, v76, s39, 0
    v_dot2_f32_bf16 v131, v76, v76, 0
    v_dot2_f32_bf16 v128, v73, s39, v128
    v_dot2_f32_bf16 v129, v73, v73, v129
    v_dot2_f32_bf16 v130, v77, s39, v130
    v_dot2_f32_bf16 v131, v77, v77, v131
    v_dot2_f32_bf16 v128, v74, s39, v128
    v_dot2_f32_bf16 v129, v74, v74, v129
    v_dot2_f32_bf16 v130, v78, s39, v130
    v_dot2_f32_bf16 v131, v78, v78, v131
    v_dot2_f32_bf16 v128, v75, s39, v128
    v_dot2_f32_bf16 v129, v75, v75, v129
    v_dot2_f32_bf16 v130, v79, s39, v130
    v_dot2_f32_bf16 v131, v79, v79, v131
    s_nop 1
    v_add_f32 v128, v128, v130
    s_nop 0
    v_add_f32 v129, v129, v131
    s_nop 0
    v_add_f32_dpp v128, v128, v128 row_ror:8 row_mask:0xf bank_mask:0xf
    v_add_f32_dpp v129, v129, v129 row_ror:8 row_mask:0xf bank_mask:0xf
    s_nop 0
    v_add_f32_dpp v128, v128, v128 row_ror:4 row_mask:0xf bank_mask:0xf
    v_add_f32_dpp v129, v129, v129 row_ror:4 row_mask:0xf bank_mask:0xf
    s_nop 0
    v_add_f32_dpp v128, v128, v128 row_ror:2 row_mask:0xf bank_mask:0xf
    v_add_f32_dpp v129, v129, v129 row_ror:2 row_mask:0xf bank_mask:0xf
    s_nop 0
    v_add_f32_dpp v128, v128, v128 row_ror:1 row_mask:0xf bank_mask:0xf
    v_add_f32_dpp v129, v129, v129 row_ror:1 row_mask:0xf bank_mask:0xf
    s_nop 0
    v_mov_b32 v130, v128
    v_mov_b32 v131, v129
    s_nop 0
    v_permlane16_swap_b32 v128, v130
    v_permlane16_swap_b32 v129, v131
    s_nop 0
    v_add_f32 v128, v128, v130
    v_add_f32 v129, v129, v131
    v_mul_f32 v128, 0x3b000000, v128
    v_mul_f32 v129, 0x3b000000, v129
    v_fma_f32 v129, -v128, v128, v129
    v_max_f32 v129, 0, v129
    v_cvt_pk_bf16_f32 v128, v128, v129
    v_and_b32 v129, 0xffff0000, v128
    v_lshlrev_b32 v128, 16, v128
    v_add_f32 v129, 0x3727c5ac, v129
    v_cvt_pk_bf16_f32 v129, v129, v129
    v_lshlrev_b32 v129, 16, v129
    v_sqrt_f32 v129, v129
    s_waitcnt vmcnt(13)
    v_lshlrev_b32 v130, 16, v80
    v_cvt_pk_bf16_f32 v129, v129, v129
    v_and_b32 v131, 0xffff0000, v80
    v_lshlrev_b32 v129, 16, v129
    v_sub_f32 v130, v130, v128
    v_rcp_f32 v129, v129
    v_sub_f32 v131, v131, v128
    v_cvt_pk_bf16_f32 v128, v130, v131
    v_lshlrev_b32 v130, 16, v128
    v_and_b32 v131, 0xffff0000, v128
    v_mul_f32 v130, v130, v129
    v_mul_f32 v131, v131, v129
    v_cvt_pk_bf16_f32 v130, v130, v130
    v_cvt_pk_bf16_f32 v131, v131, v131
    ds_write2_b32 v6, v130, v131 offset0:0 offset1:16
    ds_read_b128 v[96:99], v7 offset:0
    ds_read_b128 v[100:103], v7 offset:16
    ds_read_b128 v[104:107], v7 offset:32
    ds_read_b128 v[108:111], v7 offset:48
    s_waitcnt lgkmcnt(0)
    s_add_u32 s36, s35, 1
    s_and_b32 s37, s36, 0xff
    v_and_b32 v116, v96, v112
    v_and_b32 v117, v96, v113
    v_and_b32 v118, v96, v114
    v_and_b32 v119, v96, v115
    s_waitcnt vmcnt(13)
    s_nop 0
    v_mfma_f32_16x16x32_bf16 v[124:127], v[116:119], v[8:11], 0
    v_and_b32 v120, v97, v112
    v_and_b32 v121, v97, v113
    v_and_b32 v122, v97, v114
    v_and_b32 v123, v97, v115
    s_waitcnt vmcnt(13)
    s_nop 0
    v_mfma_f32_16x16x32_bf16 v[124:127], v[120:123], v[12:15], v[124:127]
    v_and_b32 v116, v98, v112
    v_and_b32 v117, v98, v113
    v_and_b32 v118, v98, v114
    v_and_b32 v119, v98, v115
    s_waitcnt vmcnt(13)
    s_nop 0
    v_mfma_f32_16x16x32_bf16 v[124:127], v[116:119], v[16:19], v[124:127]
    v_and_b32 v120, v99, v112
    v_and_b32 v121, v99, v113
    v_and_b32 v122, v99, v114
    v_and_b32 v123, v99, v115
    s_waitcnt vmcnt(12)
    s_nop 0
    v_mfma_f32_16x16x32_bf16 v[124:127], v[120:123], v[20:23], v[124:127]
    v_and_b32 v116, v100, v112
    v_and_b32 v117, v100, v113
    v_and_b32 v118, v100, v114
    v_and_b32 v119, v100, v115
    s_waitcnt vmcnt(11)
    s_nop 0
    v_mfma_f32_16x16x32_bf16 v[124:127], v[116:119], v[24:27], v[124:127]
    v_and_b32 v120, v101, v112
    v_and_b32 v121, v101, v113
    v_and_b32 v122, v101, v114
    v_and_b32 v123, v101, v115
    s_waitcnt vmcnt(10)
    s_nop 0
    v_mfma_f32_16x16x32_bf16 v[124:127], v[120:123], v[28:31], v[124:127]
    v_and_b32 v116, v102, v112
    v_and_b32 v117, v102, v113
    v_and_b32 v118, v102, v114
    v_and_b32 v119, v102, v115
    s_waitcnt vmcnt(9)
    s_nop 0
    v_mfma_f32_16x16x32_bf16 v[124:127], v[116:119], v[32:35], v[124:127]
    v_and_b32 v120, v103, v112
    v_and_b32 v121, v103, v113
    v_and_b32 v122, v103, v114
    v_and_b32 v123, v103, v115
    s_waitcnt vmcnt(8)
    s_nop 0
    v_mfma_f32_16x16x32_bf16 v[124:127], v[120:123], v[36:39], v[124:127]
    v_and_b32 v116, v104, v112
    v_and_b32 v117, v104, v113
    v_and_b32 v118, v104, v114
    v_and_b32 v119, v104, v115
    s_waitcnt vmcnt(7)
    s_nop 0
    v_mfma_f32_16x16x32_bf16 v[124:127], v[116:119], v[40:43], v[124:127]
    v_and_b32 v120, v105, v112
    v_and_b32 v121, v105, v113
    v_and_b32 v122, v105, v114
    v_and_b32 v123, v105, v115
    s_waitcnt vmcnt(6)
    s_nop 0
    v_mfma_f32_16x16x32_bf16 v[124:127], v[120:123], v[44:47], v[124:127]
    v_and_b32 v116, v106, v112
    v_and_b32 v117, v106, v113
    v_and_b32 v118, v106, v114
    v_and_b32 v119, v106, v115
    s_waitcnt vmcnt(5)
    s_nop 0
    v_mfma_f32_16x16x32_bf16 v[124:127], v[116:119], v[48:51], v[124:127]
    v_and_b32 v120, v107, v112
    v_and_b32 v121, v107, v113
    v_and_b32 v122, v107, v114
    v_and_b32 v123, v107, v115
    s_waitcnt vmcnt(4)
    s_nop 0
    v_mfma_f32_16x16x32_bf16 v[124:127], v[120:123], v[52:55], v[124:127]
    v_and_b32 v116, v108, v112
    v_and_b32 v117, v108, v113
    v_and_b32 v118, v108, v114
    v_and_b32 v119, v108, v115
    s_waitcnt vmcnt(3)
    s_nop 0
    v_mfma_f32_16x16x32_bf16 v[124:127], v[116:119], v[56:59], v[124:127]
    v_and_b32 v120, v109, v112
    v_and_b32 v121, v109, v113
    v_and_b32 v122, v109, v114
    v_and_b32 v123, v109, v115
    s_waitcnt vmcnt(2)
    s_nop 0
    v_mfma_f32_16x16x32_bf16 v[124:127], v[120:123], v[60:63], v[124:127]
    v_and_b32 v116, v110, v112
    v_and_b32 v117, v110, v113
    v_and_b32 v118, v110, v114
    v_and_b32 v119, v110, v115
    s_waitcnt vmcnt(1)
    s_nop 0
    v_mfma_f32_16x16x32_bf16 v[124:127], v[116:119], v[64:67], v[124:127]
    v_and_b32 v120, v111, v112
    v_and_b32 v121, v111, v113
    v_and_b32 v122, v111, v114
    v_and_b32 v123, v111, v115
    s_waitcnt vmcnt(0)
    s_nop 0
    v_mfma_f32_16x16x32_bf16 v[124:127], v[120:123], v[68:71], v[124:127]
    v_lshrrev_b32 v6, 5, v0
    v_and_b32 v7, 31, v0
    v_lshlrev_b32 v128, 12, v6
    v_lshl_add_u32 v128, v7, 4, v128
    v_lshlrev_b32 v7, 4, v5
    v_lshl_add_u32 v7, v6, 2, v7
    v_and_b32 v6, 1, v3
    v_lshl_add_u32 v7, v6, 3, v7
    v_add_u32 v124, 0x80, v124
    v_add_u32 v125, 0x80, v125
    v_add_u32 v126, 0x80, v126
    v_add_u32 v127, 0x80, v127
    v_and_or_b32 v124, v124, v132, s37
    v_and_or_b32 v125, v125, v132, s37
    v_and_or_b32 v126, v126, v132, s37
    v_and_or_b32 v127, v127, v132, s37
    buffer_store_dwordx4 v[124:127], v1, s[56:59], s69 offen
    buffer_store_dwordx4 v[124:127], v1, s[56:59], s68 offen sc1
    s_cmp_eq_u32 s32, 3
    s_cbranch_scc1 L_svc_end
    s_lshl_b32 s52, s30, 4
    s_add_u32 s52, s52, s31
    s_lshl_b32 s52, s52, 9
    s_add_u32 s53, s52, 65536
    s_add_u32 s52, s53, 1048576
    s_waitcnt vmcnt(0)
    s_mov_b32 s76, 65536
L_qpoll:
    s_cmp_eq_u32 s76, 65524
    s_cselect_b32 s52, s53, s52
    buffer_load_dwordx4 v[8:11], v128, s[56:59], s52 offen offset:0 sc1
    buffer_load_dwordx4 v[12:15], v128, s[56:59], s52 offen offset:1024 sc1
    buffer_load_dwordx4 v[16:19], v128, s[56:59], s52 offen offset:2048 sc1
    buffer_load_dwordx4 v[20:23], v128, s[56:59], s52 offen offset:3072 sc1
    s_waitcnt vmcnt(3)
    v_xor_b32 v8, s37, v8
    v_xor_b32 v9, s37, v9
    v_xor_b32 v10, s37, v10
    v_xor_b32 v11, s37, v11
    v_or3_b32 v96, v8, v9, v10
    s_waitcnt vmcnt(2)
    v_xor_b32 v12, s37, v12
    v_xor_b32 v13, s37, v13
    v_xor_b32 v14, s37, v14
    v_xor_b32 v15, s37, v15
    v_or3_b32 v96, v96, v11, v12
    v_or3_b32 v96, v96, v13, v14
    s_waitcnt vmcnt(1)
    v_xor_b32 v16, s37, v16
    v_xor_b32 v17, s37, v17
    v_xor_b32 v18, s37, v18
    v_xor_b32 v19, s37, v19
    v_or3_b32 v96, v96, v15, v16
    v_or3_b32 v96, v96, v17, v18
    s_waitcnt vmcnt(0)
    v_xor_b32 v20, s37, v20
    v_xor_b32 v21, s37, v21
    v_xor_b32 v22, s37, v22
    v_xor_b32 v23, s37, v23
    v_or3_b32 v96, v96, v19, v20
    v_or3_b32 v96, v96, v21, v22
    v_or_b32 v96, v96, v23
    v_cmp_ne_u32_sdwa vcc, v96, v2 src0_sel:BYTE_0 src1_sel:DWORD
    s_cbranch_vccz L_qpoll_ok0
    s_sub_u32 s76, s76, 1
    s_cbranch_scc0 L_qpoll
L_qpoll_ok0:
    v_pk_add_f32 v[72:73], v[8:9], v[12:13]
    v_pk_add_f32 v[74:75], v[10:11], v[14:15]
    v_pk_add_f32 v[72:73], v[72:73], v[16:17]
    v_pk_add_f32 v[74:75], v[74:75], v[18:19]
    v_pk_add_f32 v[72:73], v[72:73], v[20:21]
    v_pk_add_f32 v[74:75], v[74:75], v[22:23]
L_qpoll_out:
    v_mov_b32 v129, 1
    s_nop 0
    v_permlane32_swap_b32 v72, v74
    v_permlane32_swap_b32 v73, v75
    s_nop 0
    v_pk_add_f32 v[72:73], v[72:73], v[74:75]
    v_cvt_pk_bf16_f32 v72, v72, v73
    ds_write_b32 v7, v72 offset:11776
    ds_write_b32 v2, v129 offset:12236
L_svc_end:
    s_endpgm
L_helper:
    v_mov_b32 v2, 0
    v_lshlrev_b32 v1, 4, v0
    s_bfe_u32 s31, s2, 0x10005
    s_lshl_b32 s64, s34, 1
    s_add_u32 s64, s64, s31
    s_min_u32 s65, s28, 3
    s_mul_i32 s66, s28, 5
    s_add_u32 s66, s66, s65
    s_add_u32 s38, s66, s64
    s_cmp_lt_u32 s28, 3
    s_cselect_b32 s65, 6, 5
    s_mov_b32 s39, 0
    s_mov_b32 s77, 8
    s_cmp_lt_u32 s64, s65
    s_cbranch_scc1 L_h_role
    s_sub_u32 s65, s64, s65
    s_cmp_eq_u32 s65, 0
    s_cselect_b32 s77, 0, s77
    s_lshl_b32 s38, s28, 1
    s_add_u32 s38, s38, s65
    s_lshl_b32 s38, s38, 2
    s_add_u32 s38, s38, s3
    s_lshr_b32 s65, s65, 1
    s_lshr_b32 s66, s3, 2
    s_or_b32 s65, s65, s66
    s_add_u32 s39, s65, 1
L_h_role:
    v_lshrrev_b32 v5, 3, v0
    v_and_b32 v6, 7, v0
    v_and_b32 v7, 6, v5
    v_xor_b32 v6, v6, v7
    v_lshlrev_b32 v6, 4, v6
    v_lshl_add_u32 v133, v5, 10, v6
    s_lshl_b32 s65, s28, 19
    s_lshl_b32 s66, s3, 16
    s_add_u32 s65, s65, s66
    s_lshl_b32 s66, s64, 7
    s_add_u32 s65, s65, s66
    s_mul_i32 s79, s3, 12288
    s_add_u32 s79, s79, 16384
    s_waitcnt lgkmcnt(0)
    s_load_dword s35, s[26:27], 0
    s_mov_b32 s48, s22
    s_mov_b32 s49, s23
    s_mov_b32 s50, 2048
    s_mov_b32 s51, 0x20000
    s_mov_b32 s52, s4
    s_mov_b32 s53, s5
    s_mov_b32 s54, 2048
    s_mov_b32 s55, 0x20000
    s_mov_b32 s56, s26
    s_mov_b32 s57, s27
    s_mov_b32 s58, 1576960
    s_mov_b32 s59, 0x20000
    s_mov_b32 s72, s12
    s_mov_b32 s73, s13
    s_mov_b32 s74, 4194304
    s_mov_b32 s75, 0x20000
    s_lshl_b32 s68, s64, 16
    s_lshl_b32 s78, s28, 19
    s_add_u32 s78, s78, s68
    s_lshl_b32 s68, s3, 13
    s_add_u32 s78, s78, s68
    v_lshlrev_b32 v128, 7, v0
    s_waitcnt lgkmcnt(0)
    s_barrier
    s_cmp_ge_u32 s3, s77
    s_cbranch_scc1 L_h_probe
    buffer_load_dword v113, v128, s[72:75], s78 offen
L_h_late:
    s_branch L_h_noprobe
L_h_probe:
    s_cmp_lg_u32 s3, 7
    s_cbranch_scc1 L_h_noprobe
    s_lshl_b32 s60, s28, 7
    s_add_u32 s60, s60, 983040
    s_add_u32 s61, s60, 8192
    s_mov_b32 s62, -1
    s_mov_b32 s63, -1
    s_mov_b64 exec, 1
    buffer_store_dword v2, v2, s[56:59], s60 offen sc1
    buffer_store_dword v2, v2, s[56:59], s61 offen sc1
    s_waitcnt vmcnt(0)
    s_memtime s[68:69]
    s_waitcnt lgkmcnt(0)
    buffer_store_dword v2, v2, s[56:59], s60 offen sc1
    s_waitcnt vmcnt(0)
    s_memtime s[66:67]
    s_waitcnt lgkmcnt(0)
    s_sub_u32 s68, s66, s68
    s_min_u32 s62, s62, s68
    s_memtime s[68:69]
    s_waitcnt lgkmcnt(0)
    buffer_store_dword v2, v2, s[56:59], s61 offen sc1
    s_waitcnt vmcnt(0)
    s_memtime s[66:67]
    s_waitcnt lgkmcnt(0)
    s_sub_u32 s68, s66, s68
    s_min_u32 s63, s63, s68
    s_memtime s[68:69]
    s_waitcnt lgkmcnt(0)
    buffer_store_dword v2, v2, s[56:59], s60 offen sc1
    s_waitcnt vmcnt(0)
    s_memtime s[66:67]
    s_waitcnt lgkmcnt(0)
    s_sub_u32 s68, s66, s68
    s_min_u32 s62, s62, s68
    s_memtime s[68:69]
    s_waitcnt lgkmcnt(0)
    buffer_store_dword v2, v2, s[56:59], s61 offen sc1
    s_waitcnt vmcnt(0)
    s_memtime s[66:67]
    s_waitcnt lgkmcnt(0)
    s_sub_u32 s68, s66, s68
    s_min_u32 s63, s63, s68
    s_memtime s[68:69]
    s_waitcnt lgkmcnt(0)
    buffer_store_dword v2, v2, s[56:59], s60 offen sc1
    s_waitcnt vmcnt(0)
    s_memtime s[66:67]
    s_waitcnt lgkmcnt(0)
    s_sub_u32 s68, s66, s68
    s_min_u32 s62, s62, s68
    s_memtime s[68:69]
    s_waitcnt lgkmcnt(0)
    buffer_store_dword v2, v2, s[56:59], s61 offen sc1
    s_waitcnt vmcnt(0)
    s_memtime s[66:67]
    s_waitcnt lgkmcnt(0)
    s_sub_u32 s68, s66, s68
    s_min_u32 s63, s63, s68
    s_lshl_b32 s68, s35, 1
    s_cmp_lt_u32 s63, s62
    s_addc_u32 s68, s68, 2
    v_mov_b32 v3, s68
    buffer_store_dword v3, v2, s[56:59], s60 offen offset:1024 sc1
    s_mov_b64 exec, -1
L_h_noprobe:
    s_barrier
    s_lshr_b32 s66, s3, 1
    s_lshl_b32 s65, s28, 2
    s_add_u32 s66, s66, s65
    s_mul_i32 s66, s66, 6144
    s_add_u32 s33, s66, 1376256
    s_and_b32 s65, s3, 1
    s_lshl_b32 s65, s65, 9
    s_add_u32 s32, s33, s65
    s_lshr_b32 s30, s28, 1
    s_lshl_b32 s30, s30, 14
    s_and_b32 s66, s28, 1
    s_lshl_b32 s66, s66, 12
    s_add_u32 s30, s30, s66
    s_lshl_b32 s66, s64, 8
    s_add_u32 s30, s30, s66
    s_add_u32 s30, s30, 524288
    s_and_b32 s66, s3, 1
    s_lshl_b32 s66, s66, 13
    s_add_u32 s30, s30, s66
    s_mov_b32 s29, 0
    s_lshl_b32 s69, s3, 8
    v_lshrrev_b32 v6, 5, v0
    v_and_b32 v7, 31, v0
    v_bfe_u32 v3, v0, 3, 1
    v_mul_u32_u24 v4, 3072, v3
    v_and_b32 v5, 7, v0
    v_lshl_add_u32 v4, v5, 4, v4
    v_lshrrev_b32 v5, 4, v0
    v_lshl_add_u32 v135, v5, 7, v4
    v_lshlrev_b32 v4, 7, v3
    v_lshl_add_u32 v4, v5, 4, v4
    s_lshl_b32 s66, s3, 9
    v_add_u32 v142, v4, v4
    v_add_u32 v142, s66, v142
    v_lshl_add_u32 v4, v3, 7, v4
    v_add_u32 v136, s66, v4
    v_mov_b32 v141, 0
    v_mov_b32 v148, 0
    v_lshlrev_b32 v137, 3, v0
    v_lshlrev_b32 v138, 11, v6
    v_lshl_add_u32 v138, v7, 3, v138
    v_mov_b32 v134, 0xffffff00
    v_mov_b32 v143, 0
    v_mov_b32 v144, 0
    v_mov_b32 v125, 0
    v_mov_b32 v146, 0
    v_bfe_u32 v3, v0, 2, 2
    v_lshl_add_u32 v3, v5, 2, v3
    v_and_b32 v4, 3, v0
    v_lshlrev_b32 v4, 3, v4
    v_lshl_add_u32 v132, v3, 7, v4
    v_add_u32 v132, s79, v132
    v_bfe_u32 v3, v3, 1, 2
    v_lshlrev_b32 v139, 5, v3
    v_bfe_u32 v3, v0, 2, 2
    v_lshl_add_u32 v127, v5, 4, v3
    v_lshl_add_u32 v127, v127, 7, v4
    v_add_u32 v127, s79, v127
    v_bfe_u32 v124, v0, 4, 1
    v_lshlrev_b32 v124, 5, v124
    v_lshl_add_u32 v124, v6, 1, v124
    v_bfe_u32 v3, v0, 3, 1
    v_lshl_add_u32 v124, v3, 2, v124
    v_bfe_u32 v3, v0, 2, 1
    v_add_u32 v124, v3, v124
    v_lshl_add_u32 v124, v124, 6, v4
    v_add_u32 v124, s79, v124
    s_cmp_eq_u32 s39, 0
    s_cbranch_scc1 L_h_fsetup
    s_cmp_eq_u32 s39, 1
    s_cbranch_scc0 L_h_wfrag
    s_lshl_b32 s40, s38, 6
    s_add_u32 s40, s40, 589824
    s_add_u32 s40, s40, s29
    s_add_u32 s41, s40, 131072
    s_add_u32 s42, s40, 262144
    s_lshr_b32 s64, s38, 3
    s_lshl_b32 s64, s64, 6
    s_bfe_u32 s65, s38, 0x20001
    s_lshl_b32 s65, s65, 2
    s_add_u32 s64, s64, s65
    s_and_b32 s65, s38, 1
    s_lshl_b32 s65, s65, 5
    s_add_u32 s64, s64, s65
    v_lshrrev_b32 v3, 2, v0
    v_and_b32 v4, 3, v0
    v_lshrrev_b32 v5, 1, v3
    v_lshlrev_b32 v142, 14, v5
    v_and_b32 v5, 1, v3
    v_lshl_add_u32 v142, v5, 12, v142
    v_and_b32 v5, 1, v0
    v_lshlrev_b32 v5, 9, v5
    v_bfe_u32 v6, v0, 1, 1
    v_lshl_add_u32 v5, v6, 4, v5
    v_add_u32 v5, s64, v5
    v_lshl_add_u32 v144, v5, 2, v142
    v_lshl_add_u32 v142, v4, 4, v142
    v_lshrrev_b32 v6, 4, v0
    v_add_lshl_u32 v143, v5, v6, 1
    v_cmp_gt_u32 vcc, 11, v3
    s_mov_b32 s44, -1
    s_mov_b32 s45, 0
    v_cndmask_b32 v147, 0, -1, vcc
    v_mov_b32 v3, 0x7ffffff0
    v_cndmask_b32 v148, v3, v142, vcc
    s_mov_b32 s46, -1
    s_mov_b32 s47, 0x00000fff
    s_add_u32 s43, s29, 524288
    buffer_load_ushort v145, v143, s[52:55], 0 offen
    s_branch L_h_wfrag
L_h_fsetup:
    v_bfe_u32 v3, v0, 4, 1
    v_and_b32 v4, 7, v0
    v_lshl_add_u32 v3, v3, 3, v4
    v_bfe_u32 v4, v0, 3, 1
    v_lshlrev_b32 v141, 11, v4
    v_lshl_add_u32 v141, v3, 4, v141
    v_lshrrev_b32 v4, 1, v141
    v_lshl_add_u32 v4, v6, 2, v4
    s_lshl_b32 s66, s3, 7
    buffer_load_dword v126, v4, s[52:55], s66 offen
    v_lshl_add_u32 v141, v6, 12, v141
    v_lshlrev_b32 v143, 2, v0
    s_lshl_b32 s66, s3, 4
    s_add_u32 s66, s66, 8192
    v_lshlrev_b32 v4, 3, v6
    v_add_u32 v144, s66, v4
    v_and_b32 v147, 7, v0
    v_lshl_add_u32 v147, v147, 4, v4
    v_bfe_u32 v3, v7, 2, 2
    v_lshlrev_b32 v3, 4, v3
    v_bfe_u32 v4, v7, 4, 1
    v_lshl_add_u32 v3, v4, 3, v3
    v_and_b32 v4, 3, v7
    v_lshl_add_u32 v3, v4, 1, v3
    v_lshl_add_u32 v3, v6, 6, v3
    s_lshl_b32 s66, s3, 7
    s_add_u32 s66, s66, 10496
    v_add_u32 v145, s66, v3
    v_and_b32 v3, 1, v0
    v_lshlrev_b32 v3, 6, v3
    v_lshl_add_u32 v3, v5, 4, v3
    v_add_u32 v3, s66, v3
    v_bfe_u32 v4, v0, 1, 3
    v_mov_b32 v6, 12256
    v_cmp_eq_u32 vcc, 0, v4
    s_nop 1
    v_cndmask_b32 v150, v6, v3, vcc
    v_cmp_eq_u32 vcc, 1, v4
    s_nop 1
    v_cndmask_b32 v151, v6, v3, vcc
    v_cmp_eq_u32 vcc, 2, v4
    s_nop 1
    v_cndmask_b32 v152, v6, v3, vcc
    v_cmp_eq_u32 vcc, 3, v4
    s_nop 1
    v_cndmask_b32 v153, v6, v3, vcc
    v_and_b32 v3, 7, v0
    v_lshlrev_b32 v3, 4, v3
    v_lshl_add_u32 v146, v5, 7, v3
    v_mov_b32 v162, 0x3b000000
    v_mov_b32 v163, 0xbdd2d3e8
    v_lshrrev_b32 v3, 2, v0
    v_mul_u32_u24 v3, 2752, v3
    v_and_b32 v4, 3, v0
    v_lshl_add_u32 v125, v4, 4, v3
L_h_wfrag:
    s_add_u32 s36, s35, 1
    s_and_b32 s37, s36, 0xff
    s_cmp_eq_u32 s39, 0
    s_cbranch_scc1 L_h_fprep
    s_branch L_h_wo
L_h_fprep:
    s_mov_b32 s40, s16
    s_mov_b32 s41, s17
    s_mov_b32 s42, 1409024
    s_mov_b32 s43, 0x20000
    s_mov_b32 s44, s18
    s_mov_b32 s45, s19
    s_mov_b32 s46, 1409024
    s_mov_b32 s47, 0x20000
    s_mul_i32 s64, s3, 176128
    s_lshl_b32 s65, s38, 6
    s_add_u32 s64, s64, s65
    s_mov_b32 s68, s64
    s_add_u32 m0, s79, 0
    s_nop 0
    buffer_load_dwordx4 v125, s[40:43], s68 offen nt lds
    s_add_u32 s68, s68, 44032
    s_add_u32 m0, s79, 1024
    s_nop 0
    buffer_load_dwordx4 v125, s[40:43], s68 offen nt lds
    s_add_u32 s68, s68, 44032
    s_add_u32 m0, s79, 2048
    s_nop 0
    buffer_load_dwordx4 v125, s[40:43], s68 offen nt lds
    s_add_u32 s68, s68, 44032
    s_add_u32 m0, s79, 3072
    s_nop 0
    buffer_load_dwordx4 v125, s[40:43], s68 offen nt lds
    s_mov_b32 s68, s64
    s_add_u32 m0, s79, 4096
    s_nop 0
    buffer_load_dwordx4 v125, s[44:47], s68 offen nt lds
    s_add_u32 s68, s68, 44032
    s_add_u32 m0, s79, 5120
    s_nop 0
    buffer_load_dwordx4 v125, s[44:47], s68 offen nt lds
    s_add_u32 s68, s68, 44032
    s_add_u32 m0, s79, 6144
    s_nop 0
    buffer_load_dwordx4 v125, s[44:47], s68 offen nt lds
    s_add_u32 s68, s68, 44032
    s_add_u32 m0, s79, 7168
    s_nop 0
    buffer_load_dwordx4 v125, s[44:47], s68 offen nt lds
    s_mov_b32 s72, s20
    s_mov_b32 s73, s21
    s_mov_b32 s74, 1409024
    s_mov_b32 s75, 0x20000
    s_lshl_b32 s65, s38, 15
    s_lshl_b32 s66, s3, 7
    s_add_u32 s65, s65, s66
    s_add_u32 m0, s79, 8192
    s_nop 0
    buffer_load_dwordx4 v133, s[72:75], s65 offen nt lds
    s_addk_i32 s65, 0x2000
    s_add_u32 m0, s79, 9216
    s_nop 0
    buffer_load_dwordx4 v133, s[72:75], s65 offen nt lds
    s_addk_i32 s65, 0x2000
    s_add_u32 m0, s79, 10240
    s_nop 0
    buffer_load_dwordx4 v133, s[72:75], s65 offen nt lds
    s_addk_i32 s65, 0x2000
    s_add_u32 m0, s79, 11264
    s_nop 0
    buffer_load_dwordx4 v133, s[72:75], s65 offen nt lds
    s_lshr_b32 s52, s38, 1
    s_lshl_b32 s52, s52, 14
    s_and_b32 s66, s38, 1
    s_lshl_b32 s66, s66, 12
    s_add_u32 s52, s52, s66
    s_lshl_b32 s66, s3, 9
    s_add_u32 s52, s52, s66
    s_add_u32 s52, s52, 589824
    s_add_u32 s54, s52, 8192
    s_lshl_b32 s40, s3, 8
    s_add_u32 s40, s40, 524288
    s_add_u32 s40, s40, s29
    s_add_u32 s41, s40, 16384
    s_add_u32 s42, s40, 32768
    s_add_u32 s43, s40, 49152
    v_mov_b32 v104, 0x3f803f80
    v_mov_b32 v105, 0x3f803f80
    v_mov_b32 v106, 0x3f803f80
    v_mov_b32 v107, 0x3f803f80
    s_waitcnt vmcnt(0)
    v_lshlrev_b32 v154, 16, v126
    v_and_b32 v155, 0xffff0000, v126
    v_xor_b32 v4, 0, v139
    v_add_u32 v4, v132, v4
    ds_read_b64_tr_b16 v[72:73], v4 offset:8192
    ds_read_b64_tr_b16 v[74:75], v4 offset:10240
    v_xor_b32 v4, 32, v139
    v_add_u32 v4, v132, v4
    ds_read_b64_tr_b16 v[76:77], v4 offset:8192
    ds_read_b64_tr_b16 v[78:79], v4 offset:10240
    v_xor_b32 v4, 64, v139
    v_add_u32 v4, v132, v4
    ds_read_b64_tr_b16 v[80:81], v4 offset:8192
    ds_read_b64_tr_b16 v[82:83], v4 offset:10240
    v_xor_b32 v4, 96, v139
    v_add_u32 v4, v132, v4
    ds_read_b64_tr_b16 v[84:85], v4 offset:8192
    ds_read_b64_tr_b16 v[86:87], v4 offset:10240
    s_waitcnt lgkmcnt(0)
    ds_read_b64_tr_b16 v[40:41], v124 offset:0
    ds_read_b64_tr_b16 v[42:43], v124 offset:512
    ds_read_b64_tr_b16 v[44:45], v124 offset:32
    ds_read_b64_tr_b16 v[46:47], v124 offset:544
    ds_read_b64_tr_b16 v[48:49], v124 offset:4096
    ds_read_b64_tr_b16 v[50:51], v124 offset:4608
    ds_read_b64_tr_b16 v[52:53], v124 offset:4128
    ds_read_b64_tr_b16 v[54:55], v124 offset:4640
    s_waitcnt lgkmcnt(0)
    ds_read_b64_tr_b16 v[56:57], v124 offset:1024
    ds_read_b64_tr_b16 v[58:59], v124 offset:1536
    ds_read_b64_tr_b16 v[60:61], v124 offset:1056
    ds_read_b64_tr_b16 v[62:63], v124 offset:1568
    ds_read_b64_tr_b16 v[64:65], v124 offset:5120
    ds_read_b64_tr_b16 v[66:67], v124 offset:5632
    ds_read_b64_tr_b16 v[68:69], v124 offset:5152
    ds_read_b64_tr_b16 v[70:71], v124 offset:5664
    s_waitcnt lgkmcnt(0)
    v_mfma_f32_16x16x32_bf16 v[8:11], v[40:43], v[104:107], 0
    v_mfma_f32_16x16x32_bf16 v[12:15], v[44:47], v[104:107], 0
    v_mfma_f32_16x16x32_bf16 v[16:19], v[48:51], v[104:107], 0
    v_mfma_f32_16x16x32_bf16 v[20:23], v[52:55], v[104:107], 0
    v_mfma_f32_16x16x32_bf16 v[8:11], v[56:59], v[104:107], v[8:11]
    v_mfma_f32_16x16x32_bf16 v[12:15], v[60:63], v[104:107], v[12:15]
    v_mfma_f32_16x16x32_bf16 v[16:19], v[64:67], v[104:107], v[16:19]
    v_mfma_f32_16x16x32_bf16 v[20:23], v[68:71], v[104:107], v[20:23]
    s_nop 7
    s_mov_b32 exec_lo, 0x01010101
    s_mov_b32 exec_hi, 0x01010101
    ds_write2_b32 v142, v8, v16 offset0:0 offset1:1
    ds_write2_b32 v142, v9, v17 offset0:2 offset1:3
    ds_write2_b32 v142, v10, v18 offset0:4 offset1:5
    ds_write2_b32 v142, v11, v19 offset0:6 offset1:7
    s_nop 0
    ds_write2_b32 v142, v12, v20 offset0:32 offset1:33
    ds_write2_b32 v142, v13, v21 offset0:34 offset1:35
    ds_write2_b32 v142, v14, v22 offset0:36 offset1:37
    ds_write2_b32 v142, v15, v23 offset0:38 offset1:39
    s_mov_b64 exec, -1
    s_waitcnt lgkmcnt(0)
    s_barrier
    ds_read_b64 v[8:9], v137 offset:0
    ds_read_b64 v[10:11], v137 offset:512
    ds_read_b64 v[12:13], v137 offset:1024
    ds_read_b64 v[14:15], v137 offset:1536
    ds_read_b64 v[16:17], v137 offset:2048
    ds_read_b64 v[18:19], v137 offset:2560
    ds_read_b64 v[20:21], v137 offset:3072
    ds_read_b64 v[22:23], v137 offset:3584
    s_waitcnt lgkmcnt(0)
    v_pk_add_f32 v[156:157], v[8:9], v[10:11]
    v_pk_add_f32 v[156:157], v[156:157], v[12:13]
    v_pk_add_f32 v[156:157], v[156:157], v[14:15]
    v_pk_add_f32 v[156:157], v[156:157], v[16:17]
    v_pk_add_f32 v[156:157], v[156:157], v[18:19]
    v_pk_add_f32 v[156:157], v[156:157], v[20:21]
    v_pk_add_f32 v[156:157], v[156:157], v[22:23]
L_h_wo:
    s_waitcnt vmcnt(0)
    s_barrier
    s_mov_b32 s72, s12
    s_mov_b32 s73, s13
    s_mov_b32 s74, 4194304
    s_mov_b32 s75, 0x20000
    s_lshl_b32 s66, s34, 1
    s_add_u32 s66, s66, s31
    s_lshl_b32 s66, s66, 7
    s_lshl_b32 s65, s28, 19
    s_add_u32 s65, s65, s66
    s_lshl_b32 s66, s3, 16
    s_add_u32 s65, s65, s66
    s_add_u32 m0, s79, 0
    s_nop 0
    buffer_load_dwordx4 v133, s[72:75], s65 offen nt lds
    s_addk_i32 s65, 0x2000
    s_add_u32 m0, s79, 1024
    s_nop 0
    buffer_load_dwordx4 v133, s[72:75], s65 offen nt lds
    s_addk_i32 s65, 0x2000
    s_add_u32 m0, s79, 2048
    s_nop 0
    buffer_load_dwordx4 v133, s[72:75], s65 offen nt lds
    s_addk_i32 s65, 0x2000
    s_add_u32 m0, s79, 3072
    s_nop 0
    buffer_load_dwordx4 v133, s[72:75], s65 offen nt lds
    s_addk_i32 s65, 0x2000
    s_add_u32 m0, s79, 4096
    s_nop 0
    buffer_load_dwordx4 v133, s[72:75], s65 offen nt lds
    s_addk_i32 s65, 0x2000
    s_add_u32 m0, s79, 5120
    s_nop 0
    buffer_load_dwordx4 v133, s[72:75], s65 offen nt lds
    s_addk_i32 s65, 0x2000
    s_add_u32 m0, s79, 6144
    s_nop 0
    buffer_load_dwordx4 v133, s[72:75], s65 offen nt lds
    s_addk_i32 s65, 0x2000
    s_add_u32 m0, s79, 7168
    s_nop 0
    buffer_load_dwordx4 v133, s[72:75], s65 offen nt lds
    s_lshl_b32 s60, s28, 7
    s_add_u32 s60, s60, 984064
    buffer_load_dword v3, v2, s[56:59], s60 offen sc1
    s_waitcnt vmcnt(0)
    v_readfirstlane_b32 s60, v3
    s_lshl_b32 s61, s36, 1
    s_add_u32 s61, s61, 1
    s_cmp_eq_u32 s60, s61
    s_cselect_b32 s29, 8192, 0
    s_add_u32 s40, s40, s29
    s_add_u32 s41, s41, s29
    s_add_u32 s42, s42, s29
    s_add_u32 s43, s43, s29
    s_add_u32 s52, s52, s29
    s_sub_u32 s54, s54, s29
    s_waitcnt vmcnt(0)
    v_bfe_u32 v3, v0, 3, 1
    v_lshlrev_b32 v3, 5, v3
    v_xor_b32 v4, 0, v3
    v_add_u32 v4, v127, v4
    v_xor_b32 v5, 64, v3
    v_add_u32 v5, v127, v5
    ds_read_b64_tr_b16 v[8:9], v4 offset:0
    ds_read_b64_tr_b16 v[10:11], v5 offset:512
    ds_read_b64_tr_b16 v[24:25], v4 offset:1024
    ds_read_b64_tr_b16 v[26:27], v5 offset:1536
    v_xor_b32 v4, 32, v3
    v_add_u32 v4, v127, v4
    v_xor_b32 v5, 96, v3
    v_add_u32 v5, v127, v5
    ds_read_b64_tr_b16 v[12:13], v4 offset:0
    ds_read_b64_tr_b16 v[14:15], v5 offset:512
    ds_read_b64_tr_b16 v[28:29], v4 offset:1024
    ds_read_b64_tr_b16 v[30:31], v5 offset:1536
    s_waitcnt lgkmcnt(0)
    v_xor_b32 v4, 64, v3
    v_add_u32 v4, v127, v4
    v_xor_b32 v5, 0, v3
    v_add_u32 v5, v127, v5
    ds_read_b64_tr_b16 v[16:17], v4 offset:0
    ds_read_b64_tr_b16 v[18:19], v5 offset:512
    ds_read_b64_tr_b16 v[32:33], v4 offset:1024
    ds_read_b64_tr_b16 v[34:35], v5 offset:1536
    v_xor_b32 v4, 96, v3
    v_add_u32 v4, v127, v4
    v_xor_b32 v5, 32, v3
    v_add_u32 v5, v127, v5
    ds_read_b64_tr_b16 v[20:21], v4 offset:0
    ds_read_b64_tr_b16 v[22:23], v5 offset:512
    ds_read_b64_tr_b16 v[36:37], v4 offset:1024
    ds_read_b64_tr_b16 v[38:39], v5 offset:1536
    s_waitcnt lgkmcnt(0)
L_h_b1:
    s_sub_u32 s53, s32, 1048576
    s_mov_b32 s76, 65536
L_b1:
    s_cmp_eq_u32 s76, 65408
    s_cselect_b32 s32, s53, s32
    buffer_load_dwordx4 v[88:91], v135, s[56:59], s32 offen offset:0 sc1
    buffer_load_dwordx4 v[92:95], v135, s[56:59], s32 offen offset:1024 sc1
    buffer_load_dwordx4 v[96:99], v135, s[56:59], s32 offen offset:2048 sc1
    s_waitcnt vmcnt(2)
    v_xor_b32 v88, s37, v88
    v_xor_b32 v89, s37, v89
    v_xor_b32 v90, s37, v90
    v_xor_b32 v91, s37, v91
    v_or3_b32 v116, v88, v89, v90
    s_waitcnt vmcnt(1)
    v_xor_b32 v92, s37, v92
    v_xor_b32 v93, s37, v93
    v_xor_b32 v94, s37, v94
    v_xor_b32 v95, s37, v95
    v_or3_b32 v116, v116, v91, v92
    v_or3_b32 v116, v116, v93, v94
    s_waitcnt vmcnt(0)
    v_xor_b32 v96, s37, v96
    v_xor_b32 v97, s37, v97
    v_xor_b32 v98, s37, v98
    v_xor_b32 v99, s37, v99
    v_or3_b32 v116, v116, v95, v96
    v_or3_b32 v116, v116, v97, v98
    v_or_b32 v116, v116, v99
    v_cmp_ne_u32_sdwa vcc, v116, v2 src0_sel:BYTE_0 src1_sel:DWORD
    s_cbranch_vccz L_b1_ok0
    s_sub_u32 s76, s76, 1
    s_cbranch_scc0 L_b1
L_b1_ok0:
    v_max3_f32 v114, v90, v94, v98
    v_sub_f32 v90, v90, v114
    v_sub_f32 v94, v94, v114
    v_sub_f32 v98, v98, v114
    v_exp_f32 v90, v90
    v_exp_f32 v94, v94
    v_exp_f32 v98, v98
    v_mul_f32 v114, v90, v91
    v_pk_mul_f32 v[112:113], v[88:89], v[90:91] op_sel_hi:[1,0]
    v_fmac_f32 v114, v94, v95
    v_pk_fma_f32 v[112:113], v[92:93], v[94:95], v[112:113] op_sel_hi:[1,0,1]
    v_fmac_f32 v114, v98, v99
    v_pk_fma_f32 v[112:113], v[96:97], v[98:99], v[112:113] op_sel_hi:[1,0,1]
    v_rcp_f32 v114, v114
    s_nop 0
    v_pk_mul_f32 v[112:113], v[112:113], v[114:115] op_sel_hi:[1,0]
L_b1_out:
    v_cvt_pk_bf16_f32 v104, v112, v113
    s_nop 1
    v_mov_b32_dpp v105, v104 row_shl:1 row_mask:0xf bank_mask:0xf
    v_mov_b32_dpp v106, v104 row_shl:2 row_mask:0xf bank_mask:0xf
    v_mov_b32_dpp v107, v104 row_shl:3 row_mask:0xf bank_mask:0xf
    v_mov_b32_dpp v108, v104 row_shl:4 row_mask:0xf bank_mask:0xf
    v_mov_b32_dpp v109, v104 row_shl:5 row_mask:0xf bank_mask:0xf
    v_mov_b32_dpp v110, v104 row_shl:6 row_mask:0xf bank_mask:0xf
    v_mov_b32_dpp v111, v104 row_shl:7 row_mask:0xf bank_mask:0xf
    v_mfma_f32_16x16x32_bf16 v[112:115], v[8:11], v[104:107], 0
    v_mfma_f32_16x16x32_bf16 v[116:119], v[12:15], v[104:107], 0
    v_mfma_f32_16x16x32_bf16 v[120:123], v[16:19], v[104:107], 0
    v_mfma_f32_16x16x32_bf16 v[124:127], v[20:23], v[104:107], 0
    v_mfma_f32_16x16x32_bf16 v[112:115], v[24:27], v[108:111], v[112:115]
    v_mfma_f32_16x16x32_bf16 v[116:119], v[28:31], v[108:111], v[116:119]
    v_mfma_f32_16x16x32_bf16 v[120:123], v[32:35], v[108:111], v[120:123]
    v_mfma_f32_16x16x32_bf16 v[124:127], v[36:39], v[108:111], v[124:127]
    s_mov_b32 exec_lo, 0x01010101
    s_mov_b32 exec_hi, 0x01010101
    s_nop 2
    ds_write_b128 v136, v[112:115] offset:12288
    s_nop 0
    ds_write_b128 v136, v[116:119] offset:12352
    s_nop 0
    ds_write_b128 v136, v[120:123] offset:12416
    s_nop 0
    ds_write_b128 v136, v[124:127] offset:12480
    s_mov_b64 exec, -1
    s_cmp_lt_u32 s3, 6
    s_waitcnt lgkmcnt(0)
    s_barrier
    s_cbranch_scc1 L_w_done
    ds_read_b64 v[88:89], v137 offset:12288
    ds_read_b64 v[90:91], v137 offset:12800
    ds_read_b64 v[92:93], v137 offset:13312
    ds_read_b64 v[94:95], v137 offset:13824
    ds_read_b64 v[96:97], v137 offset:14336
    ds_read_b64 v[98:99], v137 offset:14848
    ds_read_b64 v[100:101], v137 offset:15360
    ds_read_b64 v[102:103], v137 offset:15872
    s_waitcnt lgkmcnt(6)
    v_pk_add_f32 v[88:89], v[88:89], v[90:91]
    s_waitcnt lgkmcnt(4)
    v_pk_add_f32 v[92:93], v[92:93], v[94:95]
    v_pk_add_f32 v[88:89], v[88:89], v[92:93]
    s_waitcnt lgkmcnt(2)
    v_pk_add_f32 v[96:97], v[96:97], v[98:99]
    s_waitcnt lgkmcnt(0)
    v_pk_add_f32 v[100:101], v[100:101], v[102:103]
    v_pk_add_f32 v[96:97], v[96:97], v[100:101]
    v_pk_add_f32 v[104:105], v[88:89], v[96:97]
    v_and_or_b32 v104, v104, v134, s37
    v_and_or_b32 v105, v105, v134, s37
    buffer_store_dwordx2 v[104:105], v138, s[56:59], s30 offen sc1
L_w_done:
    s_barrier
    s_cmp_eq_u32 s39, 1
    s_cbranch_scc1 L_rrole
    s_cmp_lg_u32 s39, 0
    s_cbranch_scc1 L_end
    v_mov_b32 v12, 0x3f803f80
    v_mov_b32 v13, 0x3f803f80
    v_mov_b32 v14, 0x3f803f80
    v_mov_b32 v15, 0x3f803f80
    s_mov_b64 s[60:61], -1
    s_mov_b64 s[62:63], -1
    s_mov_b64 s[64:65], -1
    s_mov_b64 s[66:67], -1
    s_mov_b32 s76, 65536
L_b2:
    s_mov_b64 exec, s[60:61]
    buffer_load_dwordx4 v[88:91], v141, s[56:59], s40 offen sc1
    s_mov_b64 exec, s[62:63]
    buffer_load_dwordx4 v[92:95], v141, s[56:59], s41 offen sc1
    s_mov_b64 exec, s[64:65]
    buffer_load_dwordx4 v[96:99], v141, s[56:59], s42 offen sc1
    s_mov_b64 exec, s[66:67]
    buffer_load_dwordx4 v[100:103], v141, s[56:59], s43 offen sc1
    s_mov_b64 exec, s[60:61]
    s_waitcnt vmcnt(3)
    v_xor_b32 v88, s37, v88
    v_xor_b32 v89, s37, v89
    v_xor_b32 v90, s37, v90
    v_xor_b32 v91, s37, v91
    v_or3_b32 v112, v88, v89, v90
    v_or_b32 v112, v112, v91
    v_cmp_ne_u32_sdwa s[60:61], v112, v2 src0_sel:BYTE_0 src1_sel:DWORD
    s_mov_b64 exec, s[62:63]
    s_waitcnt vmcnt(2)
    v_xor_b32 v92, s37, v92
    v_xor_b32 v93, s37, v93
    v_xor_b32 v94, s37, v94
    v_xor_b32 v95, s37, v95
    v_or3_b32 v112, v92, v93, v94
    v_or_b32 v112, v112, v95
    v_cmp_ne_u32_sdwa s[62:63], v112, v2 src0_sel:BYTE_0 src1_sel:DWORD
    s_mov_b64 exec, s[64:65]
    s_waitcnt vmcnt(1)
    v_xor_b32 v96, s37, v96
    v_xor_b32 v97, s37, v97
    v_xor_b32 v98, s37, v98
    v_xor_b32 v99, s37, v99
    v_or3_b32 v112, v96, v97, v98
    v_or_b32 v112, v112, v99
    v_cmp_ne_u32_sdwa s[64:65], v112, v2 src0_sel:BYTE_0 src1_sel:DWORD
    s_mov_b64 exec, s[66:67]
    s_waitcnt vmcnt(0)
    v_xor_b32 v100, s37, v100
    v_xor_b32 v101, s37, v101
    v_xor_b32 v102, s37, v102
    v_xor_b32 v103, s37, v103
    v_or3_b32 v112, v100, v101, v102
    v_or_b32 v112, v112, v103
    v_cmp_ne_u32_sdwa s[66:67], v112, v2 src0_sel:BYTE_0 src1_sel:DWORD
    s_sub_u32 s76, s76, 1
    s_cbranch_scc1 L_b2_out
    s_or_b64 vcc, s[60:61], s[62:63]
    s_or_b64 vcc, vcc, s[64:65]
    s_or_b64 vcc, vcc, s[66:67]
    s_cbranch_scc1 L_b2
L_b2_out:
    s_mov_b64 exec, -1
    v_pk_add_f32 v[88:89], v[88:89], v[92:93]
    v_pk_add_f32 v[90:91], v[90:91], v[94:95]
    v_pk_add_f32 v[96:97], v[96:97], v[100:101]
    v_pk_add_f32 v[98:99], v[98:99], v[102:103]
    v_pk_add_f32 v[88:89], v[88:89], v[96:97]
    v_pk_add_f32 v[90:91], v[90:91], v[98:99]
    s_nop 1
    v_permlane32_swap_b32 v88, v90
    v_permlane32_swap_b32 v89, v91
    v_pk_add_f32 v[88:89], v[88:89], v[154:155]
    v_pk_add_f32 v[88:89], v[88:89], v[90:91]
    v_cvt_pk_bf16_f32 v104, v88, v89
    s_nop 1
    v_mov_b32_dpp v105, v104 row_shl:1 row_mask:0xf bank_mask:0xf
    v_mov_b32_dpp v106, v104 row_shl:2 row_mask:0xf bank_mask:0xf
    v_mov_b32_dpp v107, v104 row_shl:3 row_mask:0xf bank_mask:0xf
    v_mov_b32_dpp v108, v104 row_shl:4 row_mask:0xf bank_mask:0xf
    v_mov_b32_dpp v109, v104 row_shl:5 row_mask:0xf bank_mask:0xf
    v_mov_b32_dpp v110, v104 row_shl:6 row_mask:0xf bank_mask:0xf
    v_mov_b32_dpp v111, v104 row_shl:7 row_mask:0xf bank_mask:0xf
    v_mfma_f32_16x16x32_bf16 v[128:131], v[104:107], v[104:107], 0
    v_mfma_f32_16x16x32_bf16 v[8:11], v[12:15], v[104:107], 0
    v_mfma_f32_16x16x32_bf16 v[112:115], v[40:43], v[104:107], 0
    v_mfma_f32_16x16x32_bf16 v[120:123], v[48:51], v[104:107], 0
    v_mfma_f32_16x16x32_bf16 v[116:119], v[44:47], v[104:107], 0
    v_mfma_f32_16x16x32_bf16 v[124:127], v[52:55], v[104:107], 0
    v_mfma_f32_16x16x32_bf16 v[128:131], v[108:111], v[108:111], v[128:131]
    v_mfma_f32_16x16x32_bf16 v[8:11], v[12:15], v[108:111], v[8:11]
    v_mfma_f32_16x16x32_bf16 v[112:115], v[56:59], v[108:111], v[112:115]
    v_mfma_f32_16x16x32_bf16 v[120:123], v[64:67], v[108:111], v[120:123]
    v_mfma_f32_16x16x32_bf16 v[116:119], v[60:63], v[108:111], v[116:119]
    v_mfma_f32_16x16x32_bf16 v[124:127], v[68:71], v[108:111], v[124:127]
    s_mov_b32 exec_lo, 1
    s_mov_b32 exec_hi, 0x100
    s_nop 1
    ds_write2_b32 v144, v8, v128 offset0:0 offset1:1
    s_mov_b32 exec_lo, 0x01010101
    s_mov_b32 exec_hi, 0x01010101
    ds_write2_b32 v142, v112, v120 offset0:0 offset1:1
    ds_write2_b32 v142, v113, v121 offset0:2 offset1:3
    ds_write2_b32 v142, v114, v122 offset0:4 offset1:5
    ds_write2_b32 v142, v115, v123 offset0:6 offset1:7
    s_nop 0
    ds_write2_b32 v142, v116, v124 offset0:32 offset1:33
    ds_write2_b32 v142, v117, v125 offset0:34 offset1:35
    ds_write2_b32 v142, v118, v126 offset0:36 offset1:37
    ds_write2_b32 v142, v119, v127 offset0:38 offset1:39
    s_mov_b64 exec, -1
    s_waitcnt lgkmcnt(0)
    s_barrier
    ds_read_b64 v[158:159], v147 offset:8192
    ds_read_b64 v[88:89], v137 offset:0
    ds_read_b64 v[90:91], v137 offset:512
    ds_read_b64 v[92:93], v137 offset:1024
    ds_read_b64 v[94:95], v137 offset:1536
    ds_read_b64 v[96:97], v137 offset:2048
    ds_read_b64 v[98:99], v137 offset:2560
    ds_read_b64 v[100:101], v137 offset:3072
    ds_read_b64 v[102:103], v137 offset:3584
    s_waitcnt lgkmcnt(8)
    v_add_f32_dpp v158, v158, v158 row_ror:4 row_mask:0xf bank_mask:0xf
    v_add_f32_dpp v159, v159, v159 row_ror:4 row_mask:0xf bank_mask:0xf
    s_waitcnt lgkmcnt(6)
    v_add_f32_dpp v158, v158, v158 row_ror:2 row_mask:0xf bank_mask:0xf
    v_add_f32_dpp v159, v159, v159 row_ror:2 row_mask:0xf bank_mask:0xf
    v_pk_add_f32 v[88:89], v[88:89], v[90:91]
    v_add_f32_dpp v158, v158, v158 row_ror:1 row_mask:0xf bank_mask:0xf
    v_add_f32_dpp v159, v159, v159 row_ror:1 row_mask:0xf bank_mask:0xf
    s_waitcnt lgkmcnt(4)
    v_pk_add_f32 v[92:93], v[92:93], v[94:95]
    v_pk_mul_f32 v[158:159], v[158:159], v[162:163] op_sel_hi:[1,0]
    s_waitcnt lgkmcnt(2)
    v_pk_add_f32 v[96:97], v[96:97], v[98:99]
    v_fma_f32 v159, -v158, v158, v159
    v_pk_add_f32 v[88:89], v[88:89], v[92:93]
    v_max_f32 v159, 0, v159
    s_waitcnt lgkmcnt(0)
    v_pk_add_f32 v[100:101], v[100:101], v[102:103]
    v_add_f32 v159, 0x3727c5ac, v159
    v_pk_fma_f32 v[88:89], v[156:157], v[158:159], v[88:89] op_sel_hi:[1,0,1] neg_lo:[1,0,0] neg_hi:[1,0,0]
    v_rsq_f32 v159, v159
    v_pk_add_f32 v[96:97], v[96:97], v[100:101]
    v_pk_add_f32 v[88:89], v[88:89], v[96:97]
    v_pk_mul_f32 v[88:89], v[88:89], v[158:159] op_sel:[0,1] op_sel_hi:[1,1]
    v_mul_f32 v92, v88, v88
    v_mul_f32 v89, v89, v88
    v_fmaak_f32 v92, v92, v163, 0xc0135761
    v_mul_f32 v92, v92, v88
    v_exp_f32 v92, v92
    s_nop 0
    v_add_f32 v92, 1.0, v92
    v_rcp_f32 v92, v92
    s_nop 0
    v_mul_f32 v89, v89, v92
    v_cvt_pk_bf16_f32 v89, v89, v89
    ds_write_b16 v145, v89
    ds_read_b128 v[88:91], v150
    ds_read_b128 v[92:95], v151
    ds_read_b128 v[96:99], v152
    ds_read_b128 v[100:103], v153
    s_waitcnt lgkmcnt(3)
    v_mfma_f32_16x16x32_bf16 v[112:115], v[72:75], v[88:91], 0
    s_waitcnt lgkmcnt(2)
    v_mfma_f32_16x16x32_bf16 v[112:115], v[76:79], v[92:95], v[112:115]
    s_waitcnt lgkmcnt(1)
    v_mfma_f32_16x16x32_bf16 v[112:115], v[80:83], v[96:99], v[112:115]
    s_waitcnt lgkmcnt(0)
    v_mfma_f32_16x16x32_bf16 v[112:115], v[84:87], v[100:103], v[112:115]
    s_mov_b32 exec_lo, 0x00ff00ff
    s_mov_b32 exec_hi, 0x00ff00ff
    s_nop 5
    v_and_or_b32 v112, v112, v134, s37
    v_and_or_b32 v113, v113, v134, s37
    v_and_or_b32 v114, v114, v134, s37
    v_and_or_b32 v115, v115, v134, s37
    buffer_store_dwordx4 v[112:115], v146, s[56:59], s54 offen sc1
    buffer_store_dwordx4 v[112:115], v146, s[56:59], s52 offen sc1
    s_endpgm
L_rrole:
    s_waitcnt vmcnt(0)
    v_and_b32 v147, s37, v147
    s_mov_b32 s58, 950272
    v_mov_b32 v8, 0
    v_mov_b32 v16, 0
    v_mov_b32 v9, 0
    v_mov_b32 v17, 0
    v_mov_b32 v10, 0
    v_mov_b32 v18, 0
    v_mov_b32 v11, 0
    v_mov_b32 v19, 0
    s_mov_b64 s[60:61], s[44:45]
    s_mov_b32 s76, 65536
L_rh:
    s_mov_b64 exec, s[60:61]
    buffer_load_dwordx4 v[8:11], v144, s[56:59], s43 offen sc1
    s_waitcnt vmcnt(0)
    v_xor_b32 v8, s37, v8
    v_xor_b32 v9, s37, v9
    v_xor_b32 v10, s37, v10
    v_xor_b32 v11, s37, v11
    v_or3_b32 v20, v8, v9, v10
    v_or_b32 v20, v20, v11
    v_cmp_ne_u32_sdwa s[60:61], v20, v2 src0_sel:BYTE_0 src1_sel:DWORD
    s_sub_u32 s76, s76, 1
    s_cbranch_scc1 L_rh_out
    s_or_b64 vcc, s[60:61], s[60:61]
    s_cbranch_scc1 L_rh
L_rh_out:
    s_mov_b64 exec, -1
    s_cmp_lg_u32 s38, 0
    s_cbranch_scc1 L_r_noepoch
    s_mov_b64 exec, 1
    v_mov_b32 v3, s36
    buffer_store_dword v3, v2, s[56:59], 0 offen sc1
L_r_noepoch:
    s_mov_b64 exec, -1
    v_permlane32_swap_b32 v8, v10
    v_permlane32_swap_b32 v9, v11
    s_nop 0
    v_pk_add_f32 v[8:9], v[8:9], v[10:11]
    s_nop 1
    v_permlane16_swap_b32 v8, v9
    s_nop 0
    v_add_f32 v8, v8, v9
    s_nop 1
    v_add_f32_dpp v8, v8, v8 row_ror:8 row_mask:0xf bank_mask:0xf
    s_nop 1
    v_add_f32_dpp v8, v8, v8 row_ror:4 row_mask:0xf bank_mask:0xf
    v_lshlrev_b32 v145, 16, v145
    v_add_f32 v145, v145, v8
    v_cvt_pk_bf16_f32 v145, v145, v145
    v_lshlrev_b32 v145, 16, v145
    s_mov_b32 s76, 65536
L_rc:
    buffer_load_dwordx4 v[24:27], v142, s[56:59], s40 offen sc1
    buffer_load_dwordx4 v[28:31], v142, s[56:59], s41 offen sc1
    buffer_load_dwordx4 v[32:35], v148, s[56:59], s42 offen sc1
    s_waitcnt vmcnt(2)
    v_xor_b32 v24, s37, v24
    v_xor_b32 v25, s37, v25
    v_xor_b32 v26, s37, v26
    v_xor_b32 v27, s37, v27
    v_or3_b32 v12, v24, v25, v26
    s_waitcnt vmcnt(1)
    v_xor_b32 v28, s37, v28
    v_xor_b32 v29, s37, v29
    v_xor_b32 v30, s37, v30
    v_xor_b32 v31, s37, v31
    v_or3_b32 v12, v12, v27, v28
    v_or3_b32 v12, v12, v29, v30
    s_waitcnt vmcnt(0)
    v_xor_b32 v32, v147, v32
    v_xor_b32 v33, v147, v33
    v_xor_b32 v34, v147, v34
    v_xor_b32 v35, v147, v35
    v_or3_b32 v12, v12, v31, v32
    v_or3_b32 v12, v12, v33, v34
    v_or_b32 v12, v12, v35
    v_cmp_ne_u32_sdwa vcc, v12, v2 src0_sel:BYTE_0 src1_sel:DWORD
    s_cbranch_vccz L_rc_ok0
    s_sub_u32 s76, s76, 1
    s_cbranch_scc0 L_rc
L_rc_ok0:
    v_pk_add_f32 v[8:9], v[24:25], v[28:29]
    v_pk_add_f32 v[10:11], v[26:27], v[30:31]
    v_pk_add_f32 v[8:9], v[8:9], v[32:33]
    v_pk_add_f32 v[10:11], v[10:11], v[34:35]
L_rc_out:
    s_nop 1
    v_permlane32_swap_b32 v8, v10
    v_permlane32_swap_b32 v9, v11
    s_nop 0
    v_pk_add_f32 v[8:9], v[8:9], v[10:11]
    s_nop 1
    v_permlane16_swap_b32 v8, v9
    s_nop 0
    v_add_f32 v8, v8, v9
    s_nop 1
    v_add_f32_dpp v8, v8, v8 row_ror:8 row_mask:0xf bank_mask:0xf
    s_nop 1
    v_add_f32_dpp v8, v8, v8 row_ror:4 row_mask:0xf bank_mask:0xf
    v_add_f32 v8, v8, v145
    v_cvt_pk_bf16_f32 v8, v8, v8
    s_mov_b32 exec_lo, 0x000f000f
    s_mov_b32 exec_hi, 0x000f000f
    buffer_store_short v8, v143, s[48:51], 0 offen
L_end:
    s_endpgm
.section .rodata,"a"
.p2align 6
.amdhsa_kernel sequential_preLN__sliding_block_cached__geglu_ffn__decode_kernel
  .amdhsa_next_free_vgpr 168
  .amdhsa_next_free_sgpr 102
  .amdhsa_accum_offset 168
  .amdhsa_group_segment_fixed_size 0
  .amdhsa_kernarg_size 96
  .amdhsa_user_sgpr_count 2
  .amdhsa_user_sgpr_kernarg_segment_ptr 1
  .amdhsa_system_sgpr_workgroup_id_x 1
.end_amdhsa_kernel
```
